```python
import torch

def _softmax(x, axis=-1):
    return torch.softmax(x, dim=axis)

def _gelu(x):
    return torch.nn.functional.gelu(x, approximate='tanh')

def _silu(x):
    return torch.nn.functional.silu(x)

def _sigmoid(x):
    return torch.sigmoid(x)

def _layernorm(x, axis=-1, eps=1e-05):
    m = x.mean(dim=axis, keepdim=True)
    v = x.var(dim=axis, keepdim=True, unbiased=False)
    return (x - m) / torch.sqrt(v + eps)

def _scatter_add(tgt, idx, src, axis=0):
    return tgt.clone().index_add_(axis, idx, src)

def _segment_sum(src, seg, n):
    out = torch.zeros((n,) + src.shape[1:], dtype=src.dtype)
    return out.index_add_(0, seg, src)

def _pad(x, pw):
    flat = tuple((v for pair in reversed(pw) for v in pair))
    return torch.nn.functional.pad(x, flat)
kernel_name = 'adaLN_cond__sliding_block_cached__mixer_token_mlp__decode'

def setup_inputs():

    _w = lambda a: (lambda t: t.to(torch.bfloat16) if t.is_floating_point() else t)(torch.as_tensor(a))

    def _A_setup():
        B, Sq, D = (1, 1, 640)
        Hq, Hkv, Sk, Dh = (32, 32, 8192, 128)
        assert Hq % Hkv == 0, (Hq, Hkv)
        return {'x': _w((lambda *s: torch.randn(*s, dtype=torch.bfloat16) * 0.05)(B, Sq, D)), 'k_cache': _w((lambda *s: torch.randn(*s, dtype=torch.bfloat16) * 1.6)(B, Hkv, Sk, Dh)), 'v_cache': _w((lambda *s: torch.randn(*s, dtype=torch.bfloat16) * 1.6)(B, Hkv, Sk, Dh)), 'wq': _w((lambda *s: torch.randn(*s, dtype=torch.bfloat16) * 1.6)(D, Hq * Dh) * D ** (-0.5)), 'wo': _w((lambda *s: torch.randn(*s, dtype=torch.bfloat16) * 1.6)(Hq * Dh, D) * (Hq * Dh) ** (-0.5))}
    _A_in = _A_setup()

    def _B_setup():
        B, S, D, F = (1, 1, 640, 1728)
        return {'x': _w((lambda *s: torch.randn(*s, dtype=torch.bfloat16) * 0.05)(B, S, D)), 'w1': _w((lambda *s: torch.randn(*s, dtype=torch.bfloat16) * 0.8)(S, F) * S ** (-0.5)), 'b1': _w((lambda *s: torch.randn(*s, dtype=torch.bfloat16) * 0.8)(F) * 0.02), 'w2': _w((lambda *s: torch.randn(*s, dtype=torch.bfloat16) * 0.8)(F, S) * F ** (-0.5)), 'b2': _w((lambda *s: torch.randn(*s, dtype=torch.bfloat16) * 0.8)(S) * 0.02)}
    _B_in = _B_setup()
    return {'A_x': _A_in['x'], 'A_k_cache': _A_in['k_cache'], 'A_v_cache': _A_in['v_cache'], 'A_wq': _A_in['wq'], 'A_wo': _A_in['wo'], 'B_x': _B_in['x'], 'B_w1': _B_in['w1'], 'B_b1': _B_in['b1'], 'B_w2': _B_in['w2'], 'B_b2': _B_in['b2'], 'c': _w((lambda *s: torch.randn(*s, dtype=torch.bfloat16) * 0.05)(1, 640) * 8.0), 'w_mod': _w((lambda *s: torch.randn(*s, dtype=torch.bfloat16) * 0.05)(640, 6 * 640) * 640 ** (-0.5) * 8.0)}

def reference(A_x, A_k_cache, A_v_cache, A_wq, A_wo, B_x, B_w1, B_b1, B_w2, B_b2, c, w_mod):

    def _A_ref(x, k_cache, v_cache, wq, wo):
        B, Sq, D = x.shape
        Hq, Dh = (32, 128)
        Hkv, Sk = (k_cache.shape[1], k_cache.shape[2])
        W = min(4096, max(256, Sk // 4))
        rep = Hq // Hkv
        q = (lambda x, *d: x.permute(*d))((x @ wq).reshape(B, Sq, Hq, Dh), 0, 2, 1, 3)
        k = (lambda x, n, axis: torch.repeat_interleave(x, n, dim=axis))(k_cache[:, :, Sk - W:, :], rep, axis=1)
        v = (lambda x, n, axis: torch.repeat_interleave(x, n, dim=axis))(v_cache[:, :, Sk - W:, :], rep, axis=1)
        scores = torch.einsum('bhqd,bhkd->bhqk', q, k) * Dh ** (-0.5)
        p = _softmax(scores, axis=-1)
        o = torch.einsum('bhqk,bhkd->bhqd', p, v)
        return (lambda x, *d: x.permute(*d))(o, 0, 2, 1, 3).reshape(B, Sq, Hq * Dh) @ wo

    def _B_ref(x, w1, b1, w2, b2):
        B, S, D = x.shape
        h = _layernorm(x, axis=-1)
        u = torch.einsum('bsd,sf->bdf', h, w1) + b1
        u = _gelu(u)
        y = torch.einsum('bdf,fs->bds', u, w2) + b2
        return (lambda x, *d: x.permute(*d))(y, 0, 2, 1)
    x = A_x
    mod = (_silu(c) @ w_mod).reshape(c.shape[0], 6, 1, -1)
    sa, ca, ga, sb, cb, gb = (mod[:, 0].clone(), mod[:, 1].clone(), mod[:, 2].clone(), mod[:, 3].clone(), mod[:, 4].clone(), mod[:, 5].clone())
    h = _layernorm(x, axis=-1) * (1 + ca) + sa
    x = x + ga * _A_ref(h, A_k_cache, A_v_cache, A_wq, A_wo)
    h = _layernorm(x, axis=-1) * (1 + cb) + sb
    x = x + gb * _B_ref(h, B_w1, B_b1, B_w2, B_b2)
    return x
```

```asm
; @launch grid=(256,1,1) block=(640,1,1) lds=27648
.amdgcn_target "amdgcn-amd-amdhsa--gfx950"
.text
.globl adaLN_cond__sliding_block_cached__mixer_token_mlp__decode_kernel
.p2align 12
.p2align 8
.type adaLN_cond__sliding_block_cached__mixer_token_mlp__decode_kernel,@function
adaLN_cond__sliding_block_cached__mixer_token_mlp__decode_kernel:
    s_cmp_ge_u32 s2, 256
    s_cbranch_scc1 L_END
    s_load_dwordx16 s[52:67], s[0:1], 0
    s_load_dwordx8 s[68:75], s[0:1], 64
    s_load_dwordx4 s[76:79], s[0:1], 96
    s_load_dwordx2 s[80:81], s[0:1], 112
    v_lshrrev_b32 v1, 6, v0
    v_and_b32 v0, 63, v0
    v_readfirstlane_b32 s3, v1
    s_and_b32 s4, s2, 7
    s_lshr_b32 s5, s2, 3
    s_and_b32 s46, s5, 0
    s_or_b32 s46, s46, s3
    s_cmp_eq_u32 s46, 0
    s_cbranch_scc0 L_nopf
    s_getpc_b64 s[46:47]
L_PC:
    v_lshlrev_b32 v161, 7, v0
    v_add_u32 v162, 0, v161
    v_min_u32 v162, L_END-L_PC, v162
    global_load_dword v164, v162, s[46:47]
    v_add_u32 v163, 8192, v161
    v_min_u32 v163, L_END-L_PC, v163
    global_load_dword v165, v163, s[46:47]
L_nopf:
    s_and_b32 s11, s5, 3
    s_lshl_b32 s6, s4, 2
    s_add_u32 s6, s6, s11
    s_lshr_b32 s7, s5, 2
    v_and_b32 v2, 15, v0
    v_lshrrev_b32 v3, 4, v0
    s_mov_b32 s30, 0x100000
    s_mov_b32 s31, 0x20000
    s_mov_b32 s23, 0x20000
    s_mov_b32 s101, 0
    s_cmp_lt_u32 s3, 8
    s_cbranch_scc1 L_KV0
    s_cmp_eq_u32 s3, 8
    s_cbranch_scc1 L_QW
L_MW:
    s_mov_b32 s98, s5
    s_mov_b32 s99, s4
    s_cmp_lt_u32 s4, 4
    s_cselect_b32 s40, 20, 0
    s_cmp_lt_u32 s5, s40
    s_cbranch_scc1 L_mgo
    s_sub_u32 s40, s5, 20
    s_cmp_lt_u32 s40, 10
    s_cbranch_scc1 L_MGATE
    s_branch L_FINISH
L_mgo:
    s_mul_i32 s42, s99, 1228800
    s_lshl_b32 s43, s98, 7
    s_add_u32 s42, s42, s43
    v_bfe_u32 v10, v0, 3, 1
    v_lshl_add_u32 v10, v10, 2, v3
    s_movk_i32 s43, 7680
    v_mul_lo_u32 v10, v10, s43
    v_and_b32 v11, 7, v0
    v_lshl_add_u32 v10, v11, 4, v10
    v_min_u32 v8, 39, v0
    v_lshlrev_b32 v8, 3, v8
    s_mul_i32 s43, s99, 320
    v_add_u32 v8, s43, v8
    s_mov_b32 s22, 1221248
    s_mov_b32 s49, 61440
    s_mov_b32 s44, 0
    s_waitcnt lgkmcnt(0)
    s_load_dword s8, s[80:81], 0
    s_mov_b32 s28, s80
    s_and_b32 s29, s81, 0xffff
    global_load_dwordx2 v[156:157], v8, s[72:73]
    s_add_u32 s20, s74, s42
    s_addc_u32 s21, s75, 0
    s_and_b32 s21, s21, 0xffff
    buffer_load_dwordx4 v[12:15], v10, s[20:23], s44 offen nt
    s_add_u32 s44, s44, s49
    buffer_load_dwordx4 v[16:19], v10, s[20:23], s44 offen nt
    s_add_u32 s44, s44, s49
    buffer_load_dwordx4 v[20:23], v10, s[20:23], s44 offen nt
    s_add_u32 s44, s44, s49
    buffer_load_dwordx4 v[24:27], v10, s[20:23], s44 offen nt
    s_add_u32 s44, s44, s49
    buffer_load_dwordx4 v[28:31], v10, s[20:23], s44 offen nt
    s_add_u32 s44, s44, s49
L_stub0:
    s_cmp_eq_u32 s101, 1
    s_cbranch_scc1 L_KV
    buffer_load_dwordx4 v[32:35], v10, s[20:23], s44 offen nt
    s_add_u32 s44, s44, s49
    buffer_load_dwordx4 v[36:39], v10, s[20:23], s44 offen nt
    s_add_u32 s44, s44, s49
    buffer_load_dwordx4 v[40:43], v10, s[20:23], s44 offen nt
    s_add_u32 s44, s44, s49
    buffer_load_dwordx4 v[44:47], v10, s[20:23], s44 offen nt
    s_add_u32 s44, s44, s49
    buffer_load_dwordx4 v[48:51], v10, s[20:23], s44 offen nt
    s_add_u32 s44, s44, s49
L_stub1:
    s_cmp_eq_u32 s101, 1
    s_cbranch_scc1 L_KV
    buffer_load_dwordx4 v[52:55], v10, s[20:23], s44 offen nt
    s_add_u32 s44, s44, s49
    buffer_load_dwordx4 v[56:59], v10, s[20:23], s44 offen nt
    s_add_u32 s44, s44, s49
    buffer_load_dwordx4 v[60:63], v10, s[20:23], s44 offen nt
    s_add_u32 s44, s44, s49
    buffer_load_dwordx4 v[64:67], v10, s[20:23], s44 offen nt
    s_add_u32 s44, s44, s49
    buffer_load_dwordx4 v[68:71], v10, s[20:23], s44 offen nt
    s_add_u32 s44, s44, s49
L_stub2:
    s_cmp_eq_u32 s101, 1
    s_cbranch_scc1 L_KV
    buffer_load_dwordx4 v[72:75], v10, s[20:23], s44 offen nt
    s_add_u32 s44, s44, s49
    buffer_load_dwordx4 v[76:79], v10, s[20:23], s44 offen nt
    s_add_u32 s44, s44, s49
    buffer_load_dwordx4 v[80:83], v10, s[20:23], s44 offen nt
    s_add_u32 s44, s44, s49
    buffer_load_dwordx4 v[84:87], v10, s[20:23], s44 offen nt
    s_add_u32 s44, s44, s49
    buffer_load_dwordx4 v[88:91], v10, s[20:23], s44 offen nt
    s_barrier
    s_barrier
    s_branch L_M2
L_QW:
    v_mul_u32_u24 v8, 20, v0
    s_mul_i32 s42, s7, 160
    v_min_u32 v9, 19, v0
    v_lshlrev_b32 v9, 3, v9
    v_add_u32 v9, s42, v9
    s_mul_i32 s42, s7, 655360
    s_lshl_b32 s43, s6, 8
    s_add_u32 s42, s42, s43
    s_mov_b32 s22, 647424
    v_lshlrev_b32 v11, 13, v3
    v_lshl_add_u32 v11, v2, 4, v11
    s_mov_b32 s44, 0
    s_mov_b32 s49, 32768
    s_waitcnt lgkmcnt(0)
    s_load_dword s8, s[80:81], 0
    s_mov_b32 s28, s80
    s_and_b32 s29, s81, 0xffff
    global_load_dwordx4 v[142:145], v8, s[52:53]
    global_load_dword v146, v8, s[52:53] offset:16
    global_load_dwordx2 v[164:165], v9, s[52:53]
    s_add_u32 s20, s58, s42
    s_addc_u32 s21, s59, 0
    s_and_b32 s21, s21, 0xffff
    s_barrier
    buffer_load_dwordx4 v[52:55], v11, s[20:23], s44 offen nt
    s_add_u32 s44, s44, s49
    buffer_load_dwordx4 v[56:59], v11, s[20:23], s44 offen nt
    s_add_u32 s44, s44, s49
    buffer_load_dwordx4 v[60:63], v11, s[20:23], s44 offen nt
    s_add_u32 s44, s44, s49
    buffer_load_dwordx4 v[64:67], v11, s[20:23], s44 offen nt
    s_add_u32 s44, s44, s49
    buffer_load_dwordx4 v[68:71], v11, s[20:23], s44 offen nt
    s_add_u32 s44, s44, s49
L_stub3:
    s_cmp_eq_u32 s101, 1
    s_cbranch_scc1 L_KV
    buffer_load_dwordx4 v[72:75], v11, s[20:23], s44 offen nt
    s_add_u32 s44, s44, s49
    buffer_load_dwordx4 v[76:79], v11, s[20:23], s44 offen nt
    s_add_u32 s44, s44, s49
    buffer_load_dwordx4 v[80:83], v11, s[20:23], s44 offen nt
    s_add_u32 s44, s44, s49
    buffer_load_dwordx4 v[84:87], v11, s[20:23], s44 offen nt
    s_add_u32 s44, s44, s49
    buffer_load_dwordx4 v[88:91], v11, s[20:23], s44 offen nt
    s_add_u32 s44, s44, s49
L_stub4:
    s_cmp_eq_u32 s101, 1
    s_cbranch_scc1 L_KV
    buffer_load_dwordx4 v[92:95], v11, s[20:23], s44 offen nt
    s_add_u32 s44, s44, s49
    buffer_load_dwordx4 v[96:99], v11, s[20:23], s44 offen nt
    s_add_u32 s44, s44, s49
    buffer_load_dwordx4 v[100:103], v11, s[20:23], s44 offen nt
    s_add_u32 s44, s44, s49
    buffer_load_dwordx4 v[104:107], v11, s[20:23], s44 offen nt
    s_add_u32 s44, s44, s49
    buffer_load_dwordx4 v[108:111], v11, s[20:23], s44 offen nt
    s_add_u32 s44, s44, s49
L_stub5:
    s_cmp_eq_u32 s101, 1
    s_cbranch_scc1 L_KV
    buffer_load_dwordx4 v[112:115], v11, s[20:23], s44 offen nt
    s_add_u32 s44, s44, s49
    buffer_load_dwordx4 v[116:119], v11, s[20:23], s44 offen nt
    s_add_u32 s44, s44, s49
    buffer_load_dwordx4 v[120:123], v11, s[20:23], s44 offen nt
    s_add_u32 s44, s44, s49
    buffer_load_dwordx4 v[124:127], v11, s[20:23], s44 offen nt
    s_add_u32 s44, s44, s49
    buffer_load_dwordx4 v[128:131], v11, s[20:23], s44 offen nt
    s_barrier
    s_branch L_Q2
L_KV0:
    s_mov_b32 s101, 1
    s_cmp_eq_u32 s3, 0
    s_cbranch_scc1 L_stub0
    s_cmp_eq_u32 s3, 1
    s_cbranch_scc1 L_stub1
    s_cmp_eq_u32 s3, 2
    s_cbranch_scc1 L_stub2
    s_cmp_eq_u32 s3, 3
    s_cbranch_scc1 L_stub3
    s_cmp_eq_u32 s3, 4
    s_cbranch_scc1 L_stub4
    s_cmp_eq_u32 s3, 5
    s_cbranch_scc1 L_stub5
L_KV:
    s_lshl_b32 s40, s6, 21
    s_lshl_b32 s41, s7, 16
    s_add_u32 s40, s40, s41
    s_add_u32 s40, s40, 1572864
    s_mov_b32 s14, 65536
    s_mov_b32 s15, 0x20000
    s_mov_b32 s19, 0x20000
    s_mov_b32 s98, 0xff
    v_and_b32 v134, 3, v0
    v_lshlrev_b32 v134, 4, v134
    v_bfe_u32 v135, v0, 2, 2
    v_lshl_or_b32 v134, v135, 8, v134
    v_lshl_or_b32 v134, v3, 6, v134
    s_mul_i32 s41, s4, 5
    s_mul_i32 s43, s5, 0
    s_add_u32 s41, s41, s43
    s_mul_i32 s43, s3, 0
    s_add_u32 s41, s41, s43
    s_lshl_b32 s42, s3, 13
    s_waitcnt lgkmcnt(0)
    s_load_dword s8, s[80:81], 0
    s_mov_b32 s28, s80
    s_and_b32 s29, s81, 0xffff
    s_add_u32 s12, s54, s40
    s_addc_u32 s13, s55, 0
    s_and_b32 s13, s13, 0xffff
    s_barrier
    s_barrier
    s_and_b32 s43, s41, 7
    s_lshl_b32 s43, s43, 10
    s_add_u32 s32, s43, s42
    buffer_load_dwordx4 v[8:11], v134, s[12:15], s32 offen nt
    s_add_u32 s41, s41, 1
    s_and_b32 s43, s41, 7
    s_lshl_b32 s43, s43, 10
    s_add_u32 s33, s43, s42
    buffer_load_dwordx4 v[12:15], v134, s[12:15], s33 offen nt
    s_add_u32 s41, s41, 1
    s_and_b32 s43, s41, 7
    s_lshl_b32 s43, s43, 10
    s_add_u32 s34, s43, s42
    buffer_load_dwordx4 v[16:19], v134, s[12:15], s34 offen nt
    s_add_u32 s41, s41, 1
    s_and_b32 s43, s41, 7
    s_lshl_b32 s43, s43, 10
    s_add_u32 s35, s43, s42
    s_add_u32 s41, s41, 1
    s_and_b32 s43, s41, 7
    s_lshl_b32 s43, s43, 10
    s_add_u32 s36, s43, s42
    s_add_u32 s41, s41, 1
    s_and_b32 s43, s41, 7
    s_lshl_b32 s43, s43, 10
    s_add_u32 s37, s43, s42
    s_add_u32 s41, s41, 1
    s_and_b32 s43, s41, 7
    s_lshl_b32 s43, s43, 10
    s_add_u32 s38, s43, s42
    s_add_u32 s41, s41, 1
    s_and_b32 s43, s41, 7
    s_lshl_b32 s43, s43, 10
    s_add_u32 s39, s43, s42
    s_add_u32 s16, s56, s40
    s_addc_u32 s17, s57, 0
    s_and_b32 s17, s17, 0xffff
    s_mov_b32 s18, 65536
    v_lshlrev_b32 v161, 4, v0
    s_cmp_ge_u32 s5, 10
    s_cselect_b32 s41, 1, 0
    s_mul_i32 s42, s41, 10
    s_sub_u32 s42, s5, s42
    s_lshl_b32 s40, s4, 1
    s_add_u32 s40, s40, s41
    s_add_u32 s99, s40, 0
    s_mul_i32 s40, s40, 327680
    s_lshl_b32 s42, s42, 7
    s_add_u32 s40, s40, s42
    s_and_b32 s41, s4, 3
    s_mul_i32 s41, s41, 10
    s_add_u32 s41, s41, s5
    s_sub_u32 s41, s41, 20
    s_add_u32 s100, s41, 0
    s_lshl_b32 s41, s41, 7
    s_lshr_b32 s42, s4, 2
    s_mul_i32 s42, s42, 2457600
    s_add_u32 s42, s42, s41
    s_add_u32 s42, s42, 2560
    s_cmp_lt_u32 s5, 20
    s_cselect_b32 s40, s40, s42
    s_cselect_b32 s20, s60, s74
    s_cselect_b32 s21, s61, s75
    s_mov_b32 s22, 2450048
    s_cmov_b32 s22, 326528
    s_movk_i32 s43, 7680
    s_cmov_b32 s43, 1280
    s_movk_i32 s44, 40
    s_cmov_b32 s44, 32
    s_cmp_lt_u32 s5, 30
    s_cselect_b32 s40, s40, 0
    s_add_u32 s20, s20, s40
    s_addc_u32 s21, s21, 0
    s_and_b32 s21, s21, 0xffff
    v_bfe_u32 v110, v0, 3, 1
    v_lshl_add_u32 v110, v110, 2, v3
    v_mul_lo_u32 v110, v110, s43
    v_and_b32 v137, 7, v0
    v_lshl_add_u32 v110, v137, 4, v110
    s_mul_i32 s45, s3, s44
    s_mul_i32 s45, s45, s43
    s_lshl_b32 s46, s43, 3
    s_cmp_lt_u32 s5, 30
    s_cselect_b32 s45, s45, 0
    s_cselect_b32 s46, s46, 0
    s_cselect_b32 s22, s22, 0
    s_cmp_eq_u32 s44, 40
    s_cselect_b32 s47, 0, 0x7ff00000
    v_add_u32 v111, s47, v110
    s_mul_i32 s47, s3, 432
    v_lshlrev_b32 v137, 3, v0
    v_add_u32 v137, s47, v137
    v_mov_b32 v144, 0
    v_mov_b32 v145, 0
    v_mov_b32 v146, 0
    v_mov_b32 v147, 0
    v_mov_b32 v148, 0
    v_mov_b32 v149, 0
    v_mov_b32 v138, 0
    v_and_b32 v120, 7, v0
    v_lshrrev_b32 v121, 1, v120
    v_and_b32 v120, 1, v120
    v_mov_b32 v122, 0xffff
    v_mov_b32 v123, 0xffff0000
    v_cmp_eq_u32 vcc, 1, v120
    v_cmp_eq_u32 s[82:83], 0, v121
    v_cmp_eq_u32 s[84:85], 1, v121
    v_cmp_eq_u32 s[86:87], 2, v121
    v_cmp_eq_u32 s[88:89], 3, v121
    v_cndmask_b32 v122, v122, v123, vcc
    v_cndmask_b32_e64 v4, 0, v122, s[82:83]
    v_cndmask_b32_e64 v5, 0, v122, s[84:85]
    v_cndmask_b32_e64 v6, 0, v122, s[86:87]
    v_cndmask_b32_e64 v7, 0, v122, s[88:89]
    v_lshrrev_b32 v138, 2, v2
    v_and_b32 v139, 3, v2
    v_cmp_eq_u32 s[90:91], 1, v139
    v_cmp_eq_u32 s[92:93], 2, v139
    v_cmp_eq_u32 s[94:95], 3, v139
    v_lshrrev_b32 v120, 3, v2
    v_lshrrev_b32 v121, 1, v3
    v_cmp_eq_u32 s[96:97], v120, v121
    v_and_b32 v121, 7, v2
    v_and_b32 v122, 1, v3
    v_lshl_add_u32 v121, v121, 1, v122
    v_lshl_add_u32 v120, v120, 4, v121
    v_lshlrev_b32 v120, 4, v120
    s_mul_i32 s40, s3, 544
    v_add_u32 v158, s40, v120
    v_and_b32 v120, 3, v0
    v_mul_u32_u24 v120, 1088, v120
    v_lshrrev_b32 v121, 2, v0
    v_lshl_add_u32 v159, v121, 4, v120
    v_and_b32 v120, 7, v0
    v_mul_u32_u24 v120, 544, v120
    v_lshrrev_b32 v121, 3, v0
    v_lshl_add_u32 v152, v121, 4, v120
    s_lshl_b32 s41, s3, 6
    v_add_u32 v152, s41, v152
    v_lshlrev_b32 v153, 4, v121
    v_add_u32 v153, s41, v153
    v_lshrrev_b32 v108, 1, v153
    v_lshl_add_u32 v151, v2, 1, v3
    v_lshlrev_b32 v151, 4, v151
    v_add_u32 v151, s40, v151
    v_and_b32 v120, 31, v0
    v_lshrrev_b32 v121, 5, v0
    s_movk_i32 s41, 3072
    v_lshlrev_b32 v154, 4, v120
    v_mad_u32_u24 v154, v121, s41, v154
    v_lshlrev_b32 v109, 3, v120
    v_mad_u32_u24 v109, v121, s41, v109
    v_lshlrev_b32 v155, 2, v121
    v_add_u32 v155, v155, v0
    v_and_b32 v155, 7, v155
    v_lshlrev_b32 v155, 4, v155
    v_lshlrev_b32 v156, 4, v120
    s_lshl_b32 s41, s3, 9
    v_add_u32 v156, s41, v156
    s_lshl_b32 s40, s3, 7
    s_add_u32 s40, s40, 7680
    s_mul_i32 s41, s3, 160
    s_lshr_b32 s42, s4, 2
    s_mul_i32 s42, s42, 1280
    s_add_u32 s41, s41, s42
    s_add_u32 s41, s41, 0
    s_cmp_eq_u32 s44, 40
    s_cselect_b32 s40, s41, s40
    v_bfe_u32 v120, v0, 3, 1
    v_lshl_add_u32 v120, v120, 2, v3
    v_lshlrev_b32 v157, 2, v120
    v_add_u32 v157, s40, v157
    v_min_u32 v120, 2, v3
    s_mul_i32 s40, s5, 3
    v_add_u32 v120, s40, v120
    v_min_u32 v120, 79, v120
    v_mul_u32_u24 v121, 205, v120
    v_lshrrev_b32 v121, 11, v121
    v_mul_u32_u24 v122, 10, v121
    v_sub_u32 v120, v120, v122
    v_lshl_add_u32 v120, v120, 3, v121
    v_lshlrev_b32 v160, 4, v120
    v_lshl_add_u32 v139, v3, 2, v139
    v_lshlrev_b32 v139, 4, v139
    v_add_u32 v139, 2880, v139
    v_mov_b32 v120, 3216
    v_cmp_eq_u32 s[82:83], 0, v138
    v_cmp_eq_u32 s[84:85], 1, v138
    v_cmp_eq_u32 s[86:87], 2, v138
    v_cmp_eq_u32 s[88:89], 3, v138
    v_cndmask_b32_e64 v140, v120, v139, s[82:83]
    v_cndmask_b32_e64 v141, v120, v139, s[84:85]
    v_cndmask_b32_e64 v142, v120, v139, s[86:87]
    v_cndmask_b32_e64 v143, v120, v139, s[88:89]
    v_mov_b32 v138, 0
    s_waitcnt vmcnt(2)
    buffer_load_dwordx4 v[20:23], v134, s[12:15], s35 offen nt
    s_waitcnt vmcnt(2)
    buffer_load_dwordx4 v[24:27], v134, s[12:15], s36 offen nt
    s_waitcnt vmcnt(2)
    buffer_load_dwordx4 v[28:31], v134, s[12:15], s37 offen nt
    s_waitcnt vmcnt(2)
    buffer_load_dwordx4 v[32:35], v134, s[12:15], s38 offen nt
    s_waitcnt vmcnt(2)
    buffer_load_dwordx4 v[36:39], v134, s[12:15], s39 offen nt
    s_waitcnt vmcnt(2)
    buffer_load_dwordx4 v[40:43], v161, s[16:19], s32 offen nt
    s_waitcnt vmcnt(2)
    buffer_load_dwordx4 v[44:47], v161, s[16:19], s33 offen nt
    s_waitcnt vmcnt(2)
    buffer_load_dwordx4 v[48:51], v161, s[16:19], s34 offen nt
    s_waitcnt vmcnt(2)
    buffer_load_dwordx4 v[52:55], v161, s[16:19], s35 offen nt
    s_waitcnt vmcnt(2)
    buffer_load_dwordx4 v[56:59], v161, s[16:19], s36 offen nt
    s_waitcnt vmcnt(2)
    buffer_load_dwordx4 v[60:63], v161, s[16:19], s37 offen nt
    s_waitcnt vmcnt(2)
    buffer_load_dwordx4 v[64:67], v161, s[16:19], s38 offen nt
    s_waitcnt vmcnt(2)
    buffer_load_dwordx4 v[68:71], v161, s[16:19], s39 offen nt
    s_waitcnt lgkmcnt(0)
    s_add_u32 s8, s8, 1
    s_and_b32 s9, s8, 0xff
    s_barrier
    ds_read_b128 v[92:95], v140
    ds_read_b128 v[96:99], v141
    ds_read_b128 v[100:103], v142
    ds_read_b128 v[104:107], v143
    ds_read_b32 v138, v138 offset:3200
    s_waitcnt vmcnt(8)
    s_waitcnt lgkmcnt(4)
    v_mfma_f32_16x16x32_bf16 v[112:115], v[8:11], v[92:95], 0
    s_waitcnt lgkmcnt(3)
    v_mfma_f32_16x16x32_bf16 v[112:115], v[12:15], v[96:99], v[112:115]
    s_waitcnt lgkmcnt(2)
    v_mfma_f32_16x16x32_bf16 v[112:115], v[16:19], v[100:103], v[112:115]
    s_waitcnt lgkmcnt(1)
    v_mfma_f32_16x16x32_bf16 v[112:115], v[20:23], v[104:107], v[112:115]
    v_mfma_f32_16x16x32_bf16 v[116:119], v[24:27], v[92:95], 0
    v_mfma_f32_16x16x32_bf16 v[116:119], v[28:31], v[96:99], v[116:119]
    v_mfma_f32_16x16x32_bf16 v[116:119], v[32:35], v[100:103], v[116:119]
    v_mfma_f32_16x16x32_bf16 v[116:119], v[36:39], v[104:107], v[116:119]
    s_cmp_eq_u32 s44, 40
    s_cbranch_scc1 L_tw1
    buffer_load_dwordx4 v[72:75], v110, s[20:23], s45 offen nt
    s_add_u32 s45, s45, s46
L_tw1:
    s_waitcnt lgkmcnt(0)
    v_readfirstlane_b32 s10, v138
    s_lshl_b32 s40, s3, 2
    v_mov_b32 v138, s40
    v_cndmask_b32_e64 v134, v112, v113, s[90:91]
    s_nop 0
    v_cndmask_b32_e64 v135, v116, v117, s[90:91]
    v_cndmask_b32_e64 v134, v134, v114, s[92:93]
    v_cndmask_b32_e64 v135, v135, v118, s[92:93]
    v_cndmask_b32_e64 v134, v134, v115, s[94:95]
    v_cndmask_b32_e64 v135, v135, v119, s[94:95]
    s_nop 0
    v_add_f32_dpp v134, v134, v134 quad_perm:[1,0,3,2] row_mask:0xf bank_mask:0xf
    v_add_f32_dpp v135, v135, v135 quad_perm:[1,0,3,2] row_mask:0xf bank_mask:0xf
    s_nop 0
    v_add_f32_dpp v134, v134, v134 quad_perm:[2,3,0,1] row_mask:0xf bank_mask:0xf
    v_add_f32_dpp v135, v135, v135 quad_perm:[2,3,0,1] row_mask:0xf bank_mask:0xf
    v_cvt_pk_bf16_f32 v136, v134, v135
    v_lshlrev_b32 v134, 16, v136
    v_and_b32 v135, 0xffff0000, v136
    v_mul_f32 v134, 0x3db504f3, v134
    v_mul_f32 v135, 0x3db504f3, v135
    v_cvt_pk_bf16_f32 v136, v134, v135
    v_lshlrev_b32 v134, 16, v136
    v_and_b32 v135, 0xffff0000, v136
    v_max_f32 v136, v134, v135
    s_nop 1
    v_max_f32_dpp v136, v136, v136 row_ror:4 row_mask:0xf bank_mask:0xf
    s_nop 1
    v_max_f32_dpp v136, v136, v136 row_ror:8 row_mask:0xf bank_mask:0xf
    v_mov_b32 v137, v136
    s_nop 1
    v_permlane16_swap_b32 v136, v137
    v_max_f32 v136, v136, v137
    v_mov_b32 v137, v136
    s_nop 1
    v_permlane32_swap_b32 v136, v137
    v_max_f32 v136, v136, v137
    s_mov_b64 exec, 1
    ds_write_b32 v138, v136 offset:3136
    s_mov_b64 exec, -1
    v_mov_b32 v137, 0
    s_waitcnt lgkmcnt(0)
    s_barrier
    ds_read_b128 v[120:123], v137 offset:3136
    ds_read_b128 v[140:143], v137 offset:3152
    s_cmp_eq_u32 s44, 40
    s_cbranch_scc1 L_tw2
    buffer_load_dwordx4 v[76:79], v110, s[20:23], s45 offen nt
    s_add_u32 s45, s45, s46
L_tw2:
    s_waitcnt lgkmcnt(0)
    v_max3_f32 v136, v120, v121, v122
    v_max3_f32 v137, v123, v140, v141
    v_max3_f32 v136, v136, v142, v143
    v_max_f32 v136, v136, v137
    v_sub_f32 v134, v134, v136
    v_sub_f32 v135, v135, v136
    v_mul_f32 v134, 0x3fb8aa3b, v134
    v_mul_f32 v135, 0x3fb8aa3b, v135
    v_exp_f32 v134, v134
    v_exp_f32 v135, v135
    v_cvt_pk_bf16_f32 v132, v134, v134
    v_cvt_pk_bf16_f32 v133, v135, v135
    v_add_f32 v137, v134, v135
    v_and_b32_dpp v8, v132, v4 row_newbcast:0 row_mask:0xf bank_mask:0xf
    v_and_b32_dpp v9, v132, v5 row_newbcast:0 row_mask:0xf bank_mask:0xf
    v_and_b32_dpp v10, v132, v6 row_newbcast:0 row_mask:0xf bank_mask:0xf
    v_and_b32_dpp v11, v132, v7 row_newbcast:0 row_mask:0xf bank_mask:0xf
    v_and_b32_dpp v12, v132, v4 row_newbcast:4 row_mask:0xf bank_mask:0xf
    v_and_b32_dpp v13, v132, v5 row_newbcast:4 row_mask:0xf bank_mask:0xf
    v_and_b32_dpp v14, v132, v6 row_newbcast:4 row_mask:0xf bank_mask:0xf
    v_and_b32_dpp v15, v132, v7 row_newbcast:4 row_mask:0xf bank_mask:0xf
    v_and_b32_dpp v16, v132, v4 row_newbcast:8 row_mask:0xf bank_mask:0xf
    v_and_b32_dpp v17, v132, v5 row_newbcast:8 row_mask:0xf bank_mask:0xf
    v_and_b32_dpp v18, v132, v6 row_newbcast:8 row_mask:0xf bank_mask:0xf
    v_and_b32_dpp v19, v132, v7 row_newbcast:8 row_mask:0xf bank_mask:0xf
    v_and_b32_dpp v20, v132, v4 row_newbcast:12 row_mask:0xf bank_mask:0xf
    v_and_b32_dpp v21, v132, v5 row_newbcast:12 row_mask:0xf bank_mask:0xf
    v_and_b32_dpp v22, v132, v6 row_newbcast:12 row_mask:0xf bank_mask:0xf
    v_and_b32_dpp v23, v132, v7 row_newbcast:12 row_mask:0xf bank_mask:0xf
    v_and_b32_dpp v24, v133, v4 row_newbcast:0 row_mask:0xf bank_mask:0xf
    v_and_b32_dpp v25, v133, v5 row_newbcast:0 row_mask:0xf bank_mask:0xf
    v_and_b32_dpp v26, v133, v6 row_newbcast:0 row_mask:0xf bank_mask:0xf
    v_and_b32_dpp v27, v133, v7 row_newbcast:0 row_mask:0xf bank_mask:0xf
    v_and_b32_dpp v28, v133, v4 row_newbcast:4 row_mask:0xf bank_mask:0xf
    v_and_b32_dpp v29, v133, v5 row_newbcast:4 row_mask:0xf bank_mask:0xf
    v_and_b32_dpp v30, v133, v6 row_newbcast:4 row_mask:0xf bank_mask:0xf
    v_and_b32_dpp v31, v133, v7 row_newbcast:4 row_mask:0xf bank_mask:0xf
    v_and_b32_dpp v32, v133, v4 row_newbcast:8 row_mask:0xf bank_mask:0xf
    v_and_b32_dpp v33, v133, v5 row_newbcast:8 row_mask:0xf bank_mask:0xf
    v_and_b32_dpp v34, v133, v6 row_newbcast:8 row_mask:0xf bank_mask:0xf
    v_and_b32_dpp v35, v133, v7 row_newbcast:8 row_mask:0xf bank_mask:0xf
    v_and_b32_dpp v36, v133, v4 row_newbcast:12 row_mask:0xf bank_mask:0xf
    v_and_b32_dpp v37, v133, v5 row_newbcast:12 row_mask:0xf bank_mask:0xf
    v_and_b32_dpp v38, v133, v6 row_newbcast:12 row_mask:0xf bank_mask:0xf
    v_and_b32_dpp v39, v133, v7 row_newbcast:12 row_mask:0xf bank_mask:0xf
    v_add_f32_dpp v137, v137, v137 row_ror:4 row_mask:0xf bank_mask:0xf
    s_nop 1
    v_add_f32_dpp v137, v137, v137 row_ror:8 row_mask:0xf bank_mask:0xf
    v_mov_b32 v139, v137
    s_nop 1
    v_permlane16_swap_b32 v137, v139
    v_add_f32 v137, v137, v139
    v_mov_b32 v139, v137
    s_nop 1
    v_permlane32_swap_b32 v137, v139
    v_add_f32 v137, v137, v139
    s_mov_b64 exec, 1
    ds_write_b32 v138, v137 offset:3168
    s_mov_b64 exec, -1
    s_lshr_b32 s40, s4, 2
    s_mul_i32 s40, s40, 10240
    s_lshl_b32 s41, s100, 8
    s_add_u32 s40, s40, s41
    s_add_u32 s40, s40, 655360
    s_mul_i32 s41, s99, 2560
    s_cmp_ge_u32 s5, 10
    s_cselect_b32 s42, 10, 0
    s_sub_u32 s42, s5, s42
    s_lshl_b32 s42, s42, 8
    s_add_u32 s41, s41, s42
    s_add_u32 s41, s41, 610304
    s_cmp_eq_u32 s44, 40
    s_cselect_b32 s100, s40, s41
    v_mov_b32 v92, s9
    v_mov_b32 v93, s8
    v_mov_b32 v94, 0xc0135761
    v_mov_b32 v95, 0xc0135761
    s_lshl_b32 s40, s6, 3
    s_add_u32 s40, s40, s7
    s_mul_i32 s40, s40, 768
    s_add_u32 s40, s40, 344064
    s_lshl_b32 s41, s6, 7
    s_lshl_b32 s42, s7, 4
    s_add_u32 s41, s41, s42
    s_add_u32 s41, s41, 606208
    v_mov_b32 v140, 0
    s_cmp_eq_u32 s44, 40
    s_cbranch_scc0 L_tg3
    buffer_load_dwordx4 v[72:75], v110, s[20:23], s45 offen nt
    s_add_u32 s45, s45, s46
    buffer_load_dwordx4 v[76:79], v110, s[20:23], s45 offen nt
    s_add_u32 s45, s45, s46
L_tg3:
    buffer_load_dwordx4 v[80:83], v110, s[20:23], s45 offen nt
    s_add_u32 s45, s45, s46
    buffer_load_dwordx4 v[84:87], v110, s[20:23], s45 offen nt
    s_add_u32 s45, s45, s46
    s_cmp_eq_u32 s44, 40
    s_cselect_b32 s47, s45, 0
    buffer_load_dwordx4 v[88:91], v111, s[20:23], s47 offen nt
    s_waitcnt vmcnt(12)
    v_mfma_f32_16x16x32_bf16 v[128:131], v[8:11], v[40:43], 0
    s_waitcnt vmcnt(11)
    v_mfma_f32_16x16x32_bf16 v[128:131], v[12:15], v[44:47], v[128:131]
    s_waitcnt vmcnt(10)
    v_mfma_f32_16x16x32_bf16 v[128:131], v[16:19], v[48:51], v[128:131]
    s_waitcnt vmcnt(9)
    v_mfma_f32_16x16x32_bf16 v[128:131], v[20:23], v[52:55], v[128:131]
    s_waitcnt vmcnt(8)
    v_mfma_f32_16x16x32_bf16 v[128:131], v[24:27], v[56:59], v[128:131]
    s_waitcnt vmcnt(7)
    v_mfma_f32_16x16x32_bf16 v[128:131], v[28:31], v[60:63], v[128:131]
    s_waitcnt vmcnt(6)
    v_mfma_f32_16x16x32_bf16 v[128:131], v[32:35], v[64:67], v[128:131]
    s_waitcnt vmcnt(5)
    v_mfma_f32_16x16x32_bf16 v[128:131], v[36:39], v[68:71], v[128:131]
    s_mov_b32 exec_lo, 0xffffffff
    s_mov_b32 exec_hi, 0x0
    s_nop 5
    ds_write_b128 v151, v[128:131] offset:3328
    s_mov_b64 exec, -1
    s_waitcnt lgkmcnt(0)
    s_barrier
    ds_read_b128 v[24:27], v152 offset:3328
    ds_read_b128 v[40:43], v140 offset:3168
    ds_read_b128 v[44:47], v140 offset:3184
    v_mov_b32 v31, v93
    s_waitcnt lgkmcnt(2)
    v_add_f32_dpp v24, v24, v24 quad_perm:[1,0,3,2] row_mask:0xf bank_mask:0xf
    v_add_f32_dpp v25, v25, v25 quad_perm:[1,0,3,2] row_mask:0xf bank_mask:0xf
    v_add_f32_dpp v26, v26, v26 quad_perm:[1,0,3,2] row_mask:0xf bank_mask:0xf
    v_add_f32_dpp v27, v27, v27 quad_perm:[1,0,3,2] row_mask:0xf bank_mask:0xf
    v_add_f32_dpp v24, v24, v24 quad_perm:[2,3,0,1] row_mask:0xf bank_mask:0xf
    v_add_f32_dpp v25, v25, v25 quad_perm:[2,3,0,1] row_mask:0xf bank_mask:0xf
    v_add_f32_dpp v26, v26, v26 quad_perm:[2,3,0,1] row_mask:0xf bank_mask:0xf
    v_add_f32_dpp v27, v27, v27 quad_perm:[2,3,0,1] row_mask:0xf bank_mask:0xf
    v_add_f32_dpp v24, v24, v24 row_half_mirror row_mask:0xf bank_mask:0xf
    v_add_f32_dpp v25, v25, v25 row_half_mirror row_mask:0xf bank_mask:0xf
    v_add_f32_dpp v26, v26, v26 row_half_mirror row_mask:0xf bank_mask:0xf
    v_add_f32_dpp v27, v27, v27 row_half_mirror row_mask:0xf bank_mask:0xf
    v_mov_b32 v30, v27
    v_mov_b32 v27, v93
    s_mov_b32 exec_lo, 0x01010101
    s_mov_b32 exec_hi, 0
    s_cmp_eq_u32 s10, 1
    s_cbranch_scc0 L_sl5
    buffer_store_dwordx4 v[24:27], v153, s[28:31], s40 offen
    buffer_store_dwordx2 v[30:31], v108, s[28:31], s40 offen offset:512
L_sd6:
    s_mov_b64 exec, -1
    s_cmp_eq_u32 s3, 7
    s_cbranch_scc0 L_noml
    s_waitcnt lgkmcnt(0)
    v_add_f32 v40, v40, v41
    v_add_f32 v42, v42, v43
    v_add_f32 v44, v44, v45
    v_add_f32 v46, v46, v47
    v_add_f32 v40, v40, v42
    v_add_f32 v44, v44, v46
    v_add_f32 v41, v40, v44
    v_mov_b32 v40, v136
    v_mov_b32 v42, 0
    v_mov_b32 v43, v93
    s_mov_b64 exec, 1
    s_cmp_eq_u32 s10, 1
    s_cbranch_scc0 L_sl7
    buffer_store_dwordx4 v[40:43], v140, s[28:31], s41 offen
L_sd8:
    s_mov_b64 exec, -1
L_noml:
    s_waitcnt lgkmcnt(0)
    s_cmp_lt_u32 s5, 20
    s_cbranch_scc0 L_NOTWO
    s_cmp_lt_u32 s3, 2
    s_cbranch_scc0 L_wo_b4
    s_lshl_b32 s40, s99, 1
    s_add_u32 s40, s40, s3
    s_lshl_b32 s41, s40, 7
    s_add_u32 s41, s41, 606208
    s_mul_i32 s40, s40, 6144
    s_add_u32 s40, s40, 344064
    s_mov_b32 s51, 0
L_poll9:
    buffer_load_dwordx4 v[40:43], v155, s[28:31], s41 offen sc1
    buffer_load_dwordx4 v[24:27], v154, s[28:31], s40 offen offset:0 sc1
    buffer_load_dwordx2 v[44:45], v109, s[28:31], s40 offen offset:512 sc1
    buffer_load_dwordx4 v[28:31], v154, s[28:31], s40 offen offset:768 sc1
    buffer_load_dwordx2 v[46:47], v109, s[28:31], s40 offen offset:1280 sc1
    buffer_load_dwordx4 v[32:35], v154, s[28:31], s40 offen offset:1536 sc1
    buffer_load_dwordx2 v[48:49], v109, s[28:31], s40 offen offset:2048 sc1
    buffer_load_dwordx4 v[36:39], v154, s[28:31], s40 offen offset:2304 sc1
    buffer_load_dwordx2 v[50:51], v109, s[28:31], s40 offen offset:2816 sc1
    s_add_u32 s51, s51, 1
    s_waitcnt vmcnt(0)
    v_bitop3_b32 v52, v27, v45, v93 bitop3:0x7e
    v_bitop3_b32 v53, v31, v47, v93 bitop3:0x7e
    v_bitop3_b32 v54, v35, v49, v93 bitop3:0x7e
    v_bitop3_b32 v55, v39, v51, v93 bitop3:0x7e
    v_xor_b32 v56, v43, v93
    v_or3_b32 v52, v52, v53, v54
    v_or3_b32 v52, v52, v55, v56
    v_cmp_ne_u32 vcc, 0, v52
    s_and_b64 exec, exec, vcc
    s_cbranch_scc0 L_pdone10
    s_cmp_lt_u32 s51, 400000
    s_cbranch_scc1 L_poll9
L_pdone10:
    s_mov_b64 exec, -1
    v_mov_b32 v42, v40
    s_nop 1
    v_max_f32_dpp v42, v42, v42 quad_perm:[1,0,3,2] row_mask:0xf bank_mask:0xf
    s_nop 1
    v_max_f32_dpp v42, v42, v42 quad_perm:[2,3,0,1] row_mask:0xf bank_mask:0xf
    s_nop 1
    v_max_f32_dpp v42, v42, v42 row_half_mirror row_mask:0xf bank_mask:0xf
    v_sub_f32 v40, v40, v42
    v_mul_f32 v40, 0x3fb8aa3b, v40
    v_exp_f32 v40, v40
    s_nop 0
    v_mul_f32 v41, v41, v40
    v_mul_f32_dpp v56, v40, v24 row_newbcast:0 row_mask:0xf bank_mask:0xf
    v_mul_f32_dpp v57, v40, v25 row_newbcast:0 row_mask:0xf bank_mask:0xf
    v_mul_f32_dpp v58, v40, v26 row_newbcast:0 row_mask:0xf bank_mask:0xf
    v_mul_f32_dpp v59, v40, v44 row_newbcast:0 row_mask:0xf bank_mask:0xf
    v_add_f32_dpp v41, v41, v41 quad_perm:[1,0,3,2] row_mask:0xf bank_mask:0xf
    v_fmac_f32_dpp v56, v40, v28 row_newbcast:1 row_mask:0xf bank_mask:0xf
    v_fmac_f32_dpp v57, v40, v29 row_newbcast:1 row_mask:0xf bank_mask:0xf
    v_fmac_f32_dpp v58, v40, v30 row_newbcast:1 row_mask:0xf bank_mask:0xf
    v_fmac_f32_dpp v59, v40, v46 row_newbcast:1 row_mask:0xf bank_mask:0xf
    v_add_f32_dpp v41, v41, v41 quad_perm:[2,3,0,1] row_mask:0xf bank_mask:0xf
    v_fmac_f32_dpp v56, v40, v32 row_newbcast:2 row_mask:0xf bank_mask:0xf
    v_fmac_f32_dpp v57, v40, v33 row_newbcast:2 row_mask:0xf bank_mask:0xf
    v_fmac_f32_dpp v58, v40, v34 row_newbcast:2 row_mask:0xf bank_mask:0xf
    v_fmac_f32_dpp v59, v40, v48 row_newbcast:2 row_mask:0xf bank_mask:0xf
    v_add_f32_dpp v41, v41, v41 row_half_mirror row_mask:0xf bank_mask:0xf
    v_fmac_f32_dpp v56, v40, v36 row_newbcast:3 row_mask:0xf bank_mask:0xf
    v_fmac_f32_dpp v57, v40, v37 row_newbcast:3 row_mask:0xf bank_mask:0xf
    v_fmac_f32_dpp v58, v40, v38 row_newbcast:3 row_mask:0xf bank_mask:0xf
    v_fmac_f32_dpp v59, v40, v50 row_newbcast:3 row_mask:0xf bank_mask:0xf
    v_rcp_f32 v41, v41
    v_mov_b32 v60, v56
    v_mov_b32 v61, v57
    v_mov_b32 v62, v58
    v_mov_b32 v63, v59
    v_permlane32_swap_b32 v56, v60
    v_permlane32_swap_b32 v57, v61
    v_permlane32_swap_b32 v58, v62
    v_permlane32_swap_b32 v59, v63
    v_add_f32 v56, v56, v60
    v_add_f32 v57, v57, v61
    v_add_f32 v58, v58, v62
    v_add_f32 v59, v59, v63
    v_mul_f32 v56, v56, v41
    v_mul_f32 v57, v57, v41
    v_mul_f32 v58, v58, v41
    v_mul_f32 v59, v59, v41
    v_cvt_pk_bf16_f32 v56, v56, v56
    v_cvt_pk_bf16_f32 v57, v57, v57
    v_cvt_pk_bf16_f32 v58, v58, v58
    v_cvt_pk_bf16_f32 v59, v59, v59
    s_mov_b32 exec_lo, 0xffffffff
    s_mov_b32 exec_hi, 0x0
    ds_write_b128 v156, v[56:59] offset:7680
    s_mov_b64 exec, -1
    s_waitcnt lgkmcnt(0)
L_wo_b4:
    s_barrier
L_GEMV:
    ds_read2_b32 v[24:25], v157 offset0:0 offset1:8
    ds_read2_b32 v[26:27], v157 offset0:16 offset1:24
    ds_read_b32 v28, v157 offset:128
    v_lshrrev_b32 v20, 2, v0
    v_lshlrev_b32 v20, 4, v20
    s_waitcnt vmcnt(0) lgkmcnt(0)
    v_and_b32 v120, v24, v4
    v_and_b32 v121, v24, v5
    v_and_b32 v122, v24, v6
    v_and_b32 v123, v24, v7
    v_and_b32 v124, v25, v4
    v_and_b32 v125, v25, v5
    v_and_b32 v126, v25, v6
    v_and_b32 v127, v25, v7
    v_mfma_f32_16x16x32_bf16 v[112:115], v[120:123], v[72:75], 0
    v_and_b32 v120, v26, v4
    v_and_b32 v121, v26, v5
    v_and_b32 v122, v26, v6
    v_and_b32 v123, v26, v7
    v_mfma_f32_16x16x32_bf16 v[112:115], v[124:127], v[76:79], v[112:115]
    v_and_b32 v124, v27, v4
    v_and_b32 v125, v27, v5
    v_and_b32 v126, v27, v6
    v_and_b32 v127, v27, v7
    v_mfma_f32_16x16x32_bf16 v[112:115], v[120:123], v[80:83], v[112:115]
    v_and_b32 v120, v28, v4
    v_and_b32 v121, v28, v5
    v_and_b32 v122, v28, v6
    v_and_b32 v123, v28, v7
    v_mfma_f32_16x16x32_bf16 v[112:115], v[124:127], v[84:87], v[112:115]
    s_cmp_eq_u32 s44, 40
    s_cbranch_scc0 L_gemv4
    v_mfma_f32_16x16x32_bf16 v[112:115], v[120:123], v[88:91], v[112:115]
L_gemv4:
    s_nop 7
    s_mov_b64 exec, s[96:97]
    ds_write_b128 v158, v[112:115] offset:9728
    s_mov_b64 exec, -1
    s_waitcnt lgkmcnt(0)
    s_barrier
    s_cmp_eq_u32 s3, 0
    s_cbranch_scc0 L_nopub4
    ds_read_b128 v[24:27], v159 offset:9728
    ds_read_b128 v[28:31], v159 offset:9984
    ds_read_b128 v[32:35], v159 offset:10272
    ds_read_b128 v[36:39], v159 offset:10528
    s_waitcnt lgkmcnt(2)
    v_add_f32 v24, v24, v28
    v_add_f32 v25, v25, v29
    v_add_f32 v26, v26, v30
    v_add_f32 v27, v27, v31
    s_waitcnt lgkmcnt(0)
    v_add_f32 v32, v32, v36
    v_add_f32 v33, v33, v37
    v_add_f32 v34, v34, v38
    v_add_f32 v35, v35, v39
    v_add_f32 v24, v24, v32
    v_add_f32 v25, v25, v33
    v_add_f32 v26, v26, v34
    v_add_f32 v27, v27, v35
    v_add_f32_dpp v24, v24, v24 quad_perm:[1,0,3,2] row_mask:0xf bank_mask:0xf
    v_add_f32_dpp v25, v25, v25 quad_perm:[1,0,3,2] row_mask:0xf bank_mask:0xf
    v_add_f32_dpp v26, v26, v26 quad_perm:[1,0,3,2] row_mask:0xf bank_mask:0xf
    v_add_f32_dpp v27, v27, v27 quad_perm:[1,0,3,2] row_mask:0xf bank_mask:0xf
    v_add_f32_dpp v24, v24, v24 quad_perm:[2,3,0,1] row_mask:0xf bank_mask:0xf
    v_add_f32_dpp v25, v25, v25 quad_perm:[2,3,0,1] row_mask:0xf bank_mask:0xf
    v_add_f32_dpp v26, v26, v26 quad_perm:[2,3,0,1] row_mask:0xf bank_mask:0xf
    v_add_f32_dpp v27, v27, v27 quad_perm:[2,3,0,1] row_mask:0xf bank_mask:0xf
    v_bfi_b32 v24, s98, v92, v24
    v_bfi_b32 v25, s98, v92, v25
    v_bfi_b32 v26, s98, v92, v26
    v_bfi_b32 v27, s98, v92, v27
    s_mov_b32 exec_lo, 0x11111111
    s_mov_b32 exec_hi, 0x11111111
    buffer_store_dwordx4 v[24:27], v20, s[28:31], s100 offen sc1
    s_mov_b64 exec, -1
L_nopub4:
    s_cmp_lt_u32 s5, 27
    s_cbranch_scc0 L_FINISH
    s_mul_i32 s47, s3, 432
    v_lshlrev_b32 v137, 3, v0
    v_add_u32 v137, s47, v137
    v_mov_b32 v138, 0
    s_mov_b32 exec_lo, 0xffffffff
    s_mov_b32 exec_hi, 0x3fffff
    global_load_dwordx2 v[144:145], v137, s[64:65]
    global_load_dwordx2 v[146:147], v137, s[66:67]
    global_load_dwordx2 v[148:149], v137, s[68:69]
    s_mov_b64 exec, -1
    global_load_ushort v150, v138, s[70:71]
    s_waitcnt vmcnt(0)
    v_lshlrev_b32 v96, 16, v144
    v_and_b32 v97, 0xffff0000, v144
    v_lshlrev_b32 v98, 16, v145
    v_and_b32 v99, 0xffff0000, v145
    v_lshlrev_b32 v100, 16, v146
    v_and_b32 v101, 0xffff0000, v146
    v_lshlrev_b32 v102, 16, v147
    v_and_b32 v103, 0xffff0000, v147
    v_lshlrev_b32 v104, 16, v148
    v_and_b32 v105, 0xffff0000, v148
    v_lshlrev_b32 v106, 16, v149
    v_and_b32 v107, 0xffff0000, v149
    v_lshlrev_b32 v150, 16, v150
    s_lshl_b32 s40, s4, 11
    s_add_u32 s40, s40, 679936
    s_mov_b32 s46, 0xbdd2d3e8
    s_mov_b32 s47, 0xbdd2d3e8
    v_lshlrev_b32 v22, 7, v2
    s_lshl_b32 s41, s3, 4
    v_lshl_add_u32 v22, v3, 2, v22
    v_add_u32 v22, s41, v22
    v_lshlrev_b32 v23, 7, v3
    v_lshl_add_u32 v23, v2, 2, v23
    v_add_u32 v23, 26880, v23
    v_cmp_eq_u32 s[42:43], 1, v2
    v_cmp_eq_u32 s[44:45], 2, v2
    s_mul_i32 s41, s5, 3
    v_add_u32 v21, s41, v3
    v_cmp_gt_u32 vcc, 80, v21
    s_mul_i32 s41, s4, 80
    v_add_u32 v21, s41, v21
    v_lshlrev_b32 v21, 1, v21
    s_and_b32 s48, vcc_lo, 0x00010001
    s_and_b32 s49, vcc_hi, 0x00000001
    s_mov_b32 s51, 0
L_poll11:
    buffer_load_dwordx4 v[24:27], v160, s[28:31], s40 offen sc1
    s_add_u32 s51, s51, 1
    s_waitcnt vmcnt(0)
    v_cmp_ne_u32 vcc, v27, v93
    s_and_b64 exec, exec, vcc
    s_cbranch_scc0 L_pdone12
    s_cmp_lt_u32 s51, 400000
    s_cbranch_scc1 L_poll11
L_pdone12:
    s_mov_b64 exec, -1
    v_readlane_b32 s32, v24, 0
    v_readlane_b32 s34, v24, 16
    v_readlane_b32 s36, v24, 32
    v_pk_fma_f32 v[28:29], s[32:33], v[96:97], v[100:101] op_sel_hi:[0,1,1]
    v_pk_fma_f32 v[30:31], s[32:33], v[98:99], v[102:103] op_sel_hi:[0,1,1]
    v_pk_fma_f32 v[32:33], s[34:35], v[96:97], v[100:101] op_sel_hi:[0,1,1]
    v_pk_fma_f32 v[34:35], s[34:35], v[98:99], v[102:103] op_sel_hi:[0,1,1]
    v_pk_fma_f32 v[36:37], s[36:37], v[96:97], v[100:101] op_sel_hi:[0,1,1]
    v_pk_fma_f32 v[38:39], s[36:37], v[98:99], v[102:103] op_sel_hi:[0,1,1]
    v_pk_mul_f32 v[40:41], v[28:29], v[28:29]
    v_pk_mul_f32 v[42:43], v[30:31], v[30:31]
    v_pk_mul_f32 v[44:45], v[32:33], v[32:33]
    v_pk_mul_f32 v[46:47], v[34:35], v[34:35]
    v_pk_mul_f32 v[48:49], v[36:37], v[36:37]
    v_pk_mul_f32 v[50:51], v[38:39], v[38:39]
    v_pk_fma_f32 v[40:41], v[40:41], s[46:47], v[94:95]
    v_pk_fma_f32 v[42:43], v[42:43], s[46:47], v[94:95]
    v_pk_fma_f32 v[44:45], v[44:45], s[46:47], v[94:95]
    v_pk_fma_f32 v[46:47], v[46:47], s[46:47], v[94:95]
    v_pk_fma_f32 v[48:49], v[48:49], s[46:47], v[94:95]
    v_pk_fma_f32 v[50:51], v[50:51], s[46:47], v[94:95]
    v_pk_mul_f32 v[40:41], v[28:29], v[40:41]
    v_pk_mul_f32 v[42:43], v[30:31], v[42:43]
    v_pk_mul_f32 v[44:45], v[32:33], v[44:45]
    v_pk_mul_f32 v[46:47], v[34:35], v[46:47]
    v_pk_mul_f32 v[48:49], v[36:37], v[48:49]
    v_pk_mul_f32 v[50:51], v[38:39], v[50:51]
    v_exp_f32 v40, v40
    v_exp_f32 v41, v41
    v_pk_mul_f32 v[28:29], v[28:29], v[104:105]
    v_exp_f32 v42, v42
    v_exp_f32 v43, v43
    v_pk_mul_f32 v[30:31], v[30:31], v[106:107]
    v_exp_f32 v44, v44
    v_exp_f32 v45, v45
    v_pk_mul_f32 v[32:33], v[32:33], v[104:105]
    v_exp_f32 v46, v46
    v_exp_f32 v47, v47
    v_pk_mul_f32 v[34:35], v[34:35], v[106:107]
    v_exp_f32 v48, v48
    v_exp_f32 v49, v49
    v_pk_mul_f32 v[36:37], v[36:37], v[104:105]
    v_exp_f32 v50, v50
    v_exp_f32 v51, v51
    v_pk_mul_f32 v[38:39], v[38:39], v[106:107]
    v_pk_add_f32 v[40:41], v[40:41], 1.0 op_sel_hi:[1,0]
    v_pk_add_f32 v[42:43], v[42:43], 1.0 op_sel_hi:[1,0]
    v_pk_add_f32 v[44:45], v[44:45], 1.0 op_sel_hi:[1,0]
    v_pk_add_f32 v[46:47], v[46:47], 1.0 op_sel_hi:[1,0]
    v_pk_add_f32 v[48:49], v[48:49], 1.0 op_sel_hi:[1,0]
    v_pk_add_f32 v[50:51], v[50:51], 1.0 op_sel_hi:[1,0]
    v_rcp_f32 v40, v40
    v_rcp_f32 v41, v41
    v_rcp_f32 v42, v42
    v_rcp_f32 v43, v43
    v_rcp_f32 v44, v44
    v_rcp_f32 v45, v45
    v_rcp_f32 v46, v46
    v_rcp_f32 v47, v47
    v_rcp_f32 v48, v48
    v_rcp_f32 v49, v49
    v_rcp_f32 v50, v50
    v_rcp_f32 v51, v51
    v_pk_mul_f32 v[28:29], v[28:29], v[40:41]
    v_pk_mul_f32 v[32:33], v[32:33], v[44:45]
    v_pk_mul_f32 v[36:37], v[36:37], v[48:49]
    v_pk_fma_f32 v[28:29], v[30:31], v[42:43], v[28:29]
    v_pk_fma_f32 v[32:33], v[34:35], v[46:47], v[32:33]
    v_pk_fma_f32 v[36:37], v[38:39], v[50:51], v[36:37]
    v_add_f32 v52, v28, v29
    v_add_f32 v53, v32, v33
    v_add_f32 v54, v36, v37
    v_add_f32_dpp v52, v52, v52 quad_perm:[1,0,3,2] row_mask:0xf bank_mask:0xf
    v_add_f32_dpp v53, v53, v53 quad_perm:[1,0,3,2] row_mask:0xf bank_mask:0xf
    v_add_f32_dpp v54, v54, v54 quad_perm:[1,0,3,2] row_mask:0xf bank_mask:0xf
    v_add_f32_dpp v52, v52, v52 quad_perm:[2,3,0,1] row_mask:0xf bank_mask:0xf
    v_add_f32_dpp v53, v53, v53 quad_perm:[2,3,0,1] row_mask:0xf bank_mask:0xf
    v_add_f32_dpp v54, v54, v54 quad_perm:[2,3,0,1] row_mask:0xf bank_mask:0xf
    v_add_f32_dpp v52, v52, v52 row_ror:4 row_mask:0xf bank_mask:0xf
    v_add_f32_dpp v53, v53, v53 row_ror:4 row_mask:0xf bank_mask:0xf
    v_add_f32_dpp v54, v54, v54 row_ror:4 row_mask:0xf bank_mask:0xf
    v_add_f32_dpp v52, v52, v52 row_ror:8 row_mask:0xf bank_mask:0xf
    v_add_f32_dpp v53, v53, v53 row_ror:8 row_mask:0xf bank_mask:0xf
    v_add_f32_dpp v54, v54, v54 row_ror:8 row_mask:0xf bank_mask:0xf
    v_cndmask_b32_e64 v52, v52, v53, s[42:43]
    v_cndmask_b32_e64 v52, v52, v54, s[44:45]
    s_mov_b32 exec_lo, 0x00070007
    s_mov_b32 exec_hi, 0x00070007
    ds_write_b32 v22, v52 offset:26880
    s_mov_b64 exec, -1
    s_waitcnt lgkmcnt(0)
    s_barrier
    s_cmp_eq_u32 s3, 0
    s_cbranch_scc0 L_FINISH
    ds_read2_b32 v[32:33], v23 offset0:0 offset1:16
    s_waitcnt lgkmcnt(0)
    v_add_f32 v32, v32, v33
    s_nop 1
    v_add_f32_dpp v32, v32, v32 quad_perm:[1,0,3,2] row_mask:0xf bank_mask:0xf
    s_nop 1
    v_add_f32_dpp v32, v32, v32 quad_perm:[2,3,0,1] row_mask:0xf bank_mask:0xf
    s_nop 1
    v_add_f32_dpp v32, v32, v32 row_ror:4 row_mask:0xf bank_mask:0xf
    s_nop 1
    v_add_f32_dpp v32, v32, v32 row_ror:8 row_mask:0xf bank_mask:0xf
    v_add_f32 v32, v32, v150
    v_fma_f32 v32, v26, v32, v25
    v_cvt_pk_bf16_f32 v32, v32, v32
    s_mov_b64 exec, s[48:49]
    global_store_short v21, v32, s[76:77]
    s_mov_b64 exec, -1
    s_branch L_FINISH
L_NOTWO:
    s_cmp_lt_u32 s5, 30
    s_cbranch_scc1 L_GEMV
    s_cmp_eq_u32 s5, 30
    s_cbranch_scc0 L_FINISH
    s_waitcnt vmcnt(0)
    s_cmp_eq_u32 s3, 0
    s_cbranch_scc0 L_imp_gather
    v_mul_u32_u24 v58, 20, v0
    global_load_dwordx4 v[60:63], v58, s[52:53]
    global_load_dword v64, v58, s[52:53] offset:16
    v_mov_b32 v99, v93
    v_mov_b32 v103, v93
    v_mov_b32 v107, v93
    v_mov_b32 v111, v93
    v_mov_b32 v115, v93
    v_mov_b32 v119, v93
    v_mov_b32 v123, v93
    v_mov_b32 v127, v93
    v_mov_b32 v131, v93
    v_mov_b32 v135, v93
    v_lshlrev_b32 v58, 1, v58
    s_lshl_b32 s41, s4, 3
    v_subrev_u32 v59, s41, v0
    v_lshlrev_b32 v59, 4, v59
    s_lshl_b32 s46, s4, 11
    s_add_u32 s46, s46, 679936
    s_mov_b64 s[42:43], 0xff
    s_lshl_b64 s[42:43], s[42:43], s41
    s_waitcnt vmcnt(0)
    v_lshlrev_b32 v76, 16, v60
    v_and_b32 v77, 0xffff0000, v60
    v_lshlrev_b32 v78, 16, v61
    v_and_b32 v79, 0xffff0000, v61
    v_lshlrev_b32 v80, 16, v62
    v_and_b32 v81, 0xffff0000, v62
    v_lshlrev_b32 v82, 16, v63
    v_and_b32 v83, 0xffff0000, v63
    v_lshlrev_b32 v84, 16, v64
    v_and_b32 v85, 0xffff0000, v64
    s_branch L_imp_b4
L_imp_gather:
    s_cmp_lt_u32 s3, 6
    s_cbranch_scc0 L_imp_gate
    v_and_b32 v20, 31, v0
    s_sub_u32 s41, s3, 1
    s_lshl_b32 s41, s41, 5
    v_add_u32 v20, s41, v20
    v_lshlrev_b32 v20, 4, v20
    v_lshrrev_b32 v21, 5, v0
    s_movk_i32 s41, 20480
    v_mad_u32_u24 v21, v21, s41, v20
    s_mov_b32 s32, 610304
    s_mov_b32 s33, 615424
    s_mov_b32 s34, 620544
    s_mov_b32 s35, 625664
    s_mov_b32 s51, 0
    s_mov_b64 s[84:85], exec
    buffer_load_dwordx4 v[24:27], v21, s[28:31], s32 offen offset:0 sc1
    buffer_load_dwordx4 v[28:31], v21, s[28:31], s32 offen offset:2560 sc1
    buffer_load_dwordx4 v[32:35], v21, s[28:31], s33 offen offset:0 sc1
    buffer_load_dwordx4 v[36:39], v21, s[28:31], s33 offen offset:2560 sc1
    buffer_load_dwordx4 v[40:43], v21, s[28:31], s34 offen offset:0 sc1
    buffer_load_dwordx4 v[44:47], v21, s[28:31], s34 offen offset:2560 sc1
    buffer_load_dwordx4 v[48:51], v21, s[28:31], s35 offen offset:0 sc1
    buffer_load_dwordx4 v[52:55], v21, s[28:31], s35 offen offset:2560 sc1
L_mp13:
    s_mov_b64 exec, s[84:85]
    s_waitcnt vmcnt(0)
    v_xor_b32 v24, v92, v24
    v_xor_b32 v25, v92, v25
    v_xor_b32 v26, v92, v26
    v_xor_b32 v27, v92, v27
    v_xor_b32 v28, v92, v28
    v_xor_b32 v29, v92, v29
    v_xor_b32 v30, v92, v30
    v_xor_b32 v31, v92, v31
    v_xor_b32 v32, v92, v32
    v_xor_b32 v33, v92, v33
    v_xor_b32 v34, v92, v34
    v_xor_b32 v35, v92, v35
    v_xor_b32 v36, v92, v36
    v_xor_b32 v37, v92, v37
    v_xor_b32 v38, v92, v38
    v_xor_b32 v39, v92, v39
    v_xor_b32 v40, v92, v40
    v_xor_b32 v41, v92, v41
    v_xor_b32 v42, v92, v42
    v_xor_b32 v43, v92, v43
    v_xor_b32 v44, v92, v44
    v_xor_b32 v45, v92, v45
    v_xor_b32 v46, v92, v46
    v_xor_b32 v47, v92, v47
    v_xor_b32 v48, v92, v48
    v_xor_b32 v49, v92, v49
    v_xor_b32 v50, v92, v50
    v_xor_b32 v51, v92, v51
    v_xor_b32 v52, v92, v52
    v_xor_b32 v53, v92, v53
    v_xor_b32 v54, v92, v54
    v_xor_b32 v55, v92, v55
    v_or3_b32 v66, v24, v25, v26
    v_or_b32 v66, v66, v27
    v_or3_b32 v66, v66, v28, v29
    v_or3_b32 v66, v66, v30, v31
    v_or3_b32 v66, v66, v32, v33
    v_or3_b32 v66, v66, v34, v35
    v_or3_b32 v66, v66, v36, v37
    v_or3_b32 v66, v66, v38, v39
    v_or3_b32 v66, v66, v40, v41
    v_or3_b32 v66, v66, v42, v43
    v_or3_b32 v66, v66, v44, v45
    v_or3_b32 v66, v66, v46, v47
    v_or3_b32 v66, v66, v48, v49
    v_or3_b32 v66, v66, v50, v51
    v_or3_b32 v66, v66, v52, v53
    v_or3_b32 v66, v66, v54, v55
    v_and_b32 v66, 0xff, v66
    v_cmp_ne_u32 vcc, 0, v66
    s_and_b64 s[84:85], exec, vcc
    s_cbranch_scc0 L_mpd14
    s_mov_b64 exec, s[84:85]
    buffer_load_dwordx4 v[24:27], v21, s[28:31], s32 offen offset:0 sc1
    buffer_load_dwordx4 v[28:31], v21, s[28:31], s32 offen offset:2560 sc1
    buffer_load_dwordx4 v[32:35], v21, s[28:31], s33 offen offset:0 sc1
    buffer_load_dwordx4 v[36:39], v21, s[28:31], s33 offen offset:2560 sc1
    buffer_load_dwordx4 v[40:43], v21, s[28:31], s34 offen offset:0 sc1
    buffer_load_dwordx4 v[44:47], v21, s[28:31], s34 offen offset:2560 sc1
    buffer_load_dwordx4 v[48:51], v21, s[28:31], s35 offen offset:0 sc1
    buffer_load_dwordx4 v[52:55], v21, s[28:31], s35 offen offset:2560 sc1
    s_add_u32 s51, s51, 1
    s_cmp_lt_u32 s51, 400000
    s_cbranch_scc1 L_mp13
L_mpd14:
    s_mov_b64 exec, -1
    v_pk_add_f32 v[136:137], v[24:25], v[40:41]
    v_pk_add_f32 v[138:139], v[26:27], v[42:43]
    v_pk_add_f32 v[140:141], v[28:29], v[44:45]
    v_pk_add_f32 v[142:143], v[30:31], v[46:47]
    v_pk_add_f32 v[144:145], v[32:33], v[48:49]
    v_pk_add_f32 v[146:147], v[34:35], v[50:51]
    v_pk_add_f32 v[148:149], v[36:37], v[52:53]
    v_pk_add_f32 v[150:151], v[38:39], v[54:55]
    v_pk_add_f32 v[136:137], v[136:137], v[144:145]
    v_pk_add_f32 v[138:139], v[138:139], v[146:147]
    v_pk_add_f32 v[140:141], v[140:141], v[148:149]
    v_pk_add_f32 v[142:143], v[142:143], v[150:151]
    v_pk_add_f32 v[136:137], v[136:137], v[140:141]
    v_pk_add_f32 v[138:139], v[138:139], v[142:143]
L_mpj15:
    v_mov_b32 v140, v136
    v_mov_b32 v141, v137
    v_mov_b32 v142, v138
    v_mov_b32 v143, v139
    v_permlane32_swap_b32 v136, v140
    v_permlane32_swap_b32 v137, v141
    v_permlane32_swap_b32 v138, v142
    v_permlane32_swap_b32 v139, v143
    v_add_f32 v136, v136, v140
    v_add_f32 v137, v137, v141
    v_add_f32 v138, v138, v142
    v_add_f32 v139, v139, v143
    s_mov_b32 exec_lo, 0xffffffff
    s_mov_b32 exec_hi, 0x0
    ds_write_b128 v20, v[136:139] offset:14080
    s_mov_b64 exec, -1
    s_branch L_imp_b4
L_imp_gate:
    s_sub_u32 s41, s3, 6
    s_mul_i32 s41, s41, 320
    v_add_u32 v20, s41, v0
    s_movk_i32 s40, 160
    v_add_u32 v68, 0, v20
    v_subrev_u32 v74, 320, v68
    v_lshlrev_b32 v68, 4, v68
    v_cmp_gt_u32 vcc, s40, v74
    s_nop 1
    v_cndmask_b32_e64 v74, 0, 1.0, vcc
    v_add_u32 v69, 64, v20
    v_subrev_u32 v76, 320, v69
    v_lshlrev_b32 v69, 4, v69
    v_cmp_gt_u32 vcc, s40, v76
    s_nop 1
    v_cndmask_b32_e64 v76, 0, 1.0, vcc
    v_add_u32 v70, 128, v20
    v_subrev_u32 v78, 320, v70
    v_lshlrev_b32 v70, 4, v70
    v_cmp_gt_u32 vcc, s40, v78
    s_nop 1
    v_cndmask_b32_e64 v78, 0, 1.0, vcc
    v_add_u32 v71, 192, v20
    v_subrev_u32 v80, 320, v71
    v_lshlrev_b32 v71, 4, v71
    v_cmp_gt_u32 vcc, s40, v80
    s_nop 1
    v_cndmask_b32_e64 v80, 0, 1.0, vcc
    v_add_u32 v72, 256, v20
    v_subrev_u32 v82, 320, v72
    v_lshlrev_b32 v72, 4, v72
    v_cmp_gt_u32 vcc, s40, v82
    s_nop 1
    v_cndmask_b32_e64 v82, 0, 1.0, vcc
    s_mov_b32 s40, 655360
    s_mov_b32 s41, 665600
    s_mov_b32 s51, 0
    s_mov_b64 s[84:85], exec
    buffer_load_dwordx4 v[24:27], v68, s[28:31], s40 offen sc1
    buffer_load_dwordx4 v[28:31], v69, s[28:31], s40 offen sc1
    buffer_load_dwordx4 v[32:35], v70, s[28:31], s40 offen sc1
    buffer_load_dwordx4 v[36:39], v71, s[28:31], s40 offen sc1
    buffer_load_dwordx4 v[40:43], v72, s[28:31], s40 offen sc1
    buffer_load_dwordx4 v[44:47], v68, s[28:31], s41 offen sc1
    buffer_load_dwordx4 v[48:51], v69, s[28:31], s41 offen sc1
    buffer_load_dwordx4 v[52:55], v70, s[28:31], s41 offen sc1
    buffer_load_dwordx4 v[56:59], v71, s[28:31], s41 offen sc1
    buffer_load_dwordx4 v[60:63], v72, s[28:31], s41 offen sc1
L_mp16:
    s_mov_b64 exec, s[84:85]
    s_waitcnt vmcnt(0)
    v_xor_b32 v24, v92, v24
    v_xor_b32 v25, v92, v25
    v_xor_b32 v26, v92, v26
    v_xor_b32 v27, v92, v27
    v_xor_b32 v28, v92, v28
    v_xor_b32 v29, v92, v29
    v_xor_b32 v30, v92, v30
    v_xor_b32 v31, v92, v31
    v_xor_b32 v32, v92, v32
    v_xor_b32 v33, v92, v33
    v_xor_b32 v34, v92, v34
    v_xor_b32 v35, v92, v35
    v_xor_b32 v36, v92, v36
    v_xor_b32 v37, v92, v37
    v_xor_b32 v38, v92, v38
    v_xor_b32 v39, v92, v39
    v_xor_b32 v40, v92, v40
    v_xor_b32 v41, v92, v41
    v_xor_b32 v42, v92, v42
    v_xor_b32 v43, v92, v43
    v_xor_b32 v44, v92, v44
    v_xor_b32 v45, v92, v45
    v_xor_b32 v46, v92, v46
    v_xor_b32 v47, v92, v47
    v_xor_b32 v48, v92, v48
    v_xor_b32 v49, v92, v49
    v_xor_b32 v50, v92, v50
    v_xor_b32 v51, v92, v51
    v_xor_b32 v52, v92, v52
    v_xor_b32 v53, v92, v53
    v_xor_b32 v54, v92, v54
    v_xor_b32 v55, v92, v55
    v_xor_b32 v56, v92, v56
    v_xor_b32 v57, v92, v57
    v_xor_b32 v58, v92, v58
    v_xor_b32 v59, v92, v59
    v_xor_b32 v60, v92, v60
    v_xor_b32 v61, v92, v61
    v_xor_b32 v62, v92, v62
    v_xor_b32 v63, v92, v63
    v_or3_b32 v66, v24, v25, v26
    v_or_b32 v66, v66, v27
    v_or3_b32 v66, v66, v28, v29
    v_or3_b32 v66, v66, v30, v31
    v_or3_b32 v66, v66, v32, v33
    v_or3_b32 v66, v66, v34, v35
    v_or3_b32 v66, v66, v36, v37
    v_or3_b32 v66, v66, v38, v39
    v_or3_b32 v66, v66, v40, v41
    v_or3_b32 v66, v66, v42, v43
    v_or3_b32 v66, v66, v44, v45
    v_or3_b32 v66, v66, v46, v47
    v_or3_b32 v66, v66, v48, v49
    v_or3_b32 v66, v66, v50, v51
    v_or3_b32 v66, v66, v52, v53
    v_or3_b32 v66, v66, v54, v55
    v_or3_b32 v66, v66, v56, v57
    v_or3_b32 v66, v66, v58, v59
    v_or3_b32 v66, v66, v60, v61
    v_or3_b32 v66, v66, v62, v63
    v_and_b32 v66, 0xff, v66
    v_cmp_ne_u32 vcc, 0, v66
    s_and_b64 s[84:85], exec, vcc
    s_cbranch_scc0 L_mpd17
    s_mov_b64 exec, s[84:85]
    buffer_load_dwordx4 v[24:27], v68, s[28:31], s40 offen sc1
    buffer_load_dwordx4 v[28:31], v69, s[28:31], s40 offen sc1
    buffer_load_dwordx4 v[32:35], v70, s[28:31], s40 offen sc1
    buffer_load_dwordx4 v[36:39], v71, s[28:31], s40 offen sc1
    buffer_load_dwordx4 v[40:43], v72, s[28:31], s40 offen sc1
    buffer_load_dwordx4 v[44:47], v68, s[28:31], s41 offen sc1
    buffer_load_dwordx4 v[48:51], v69, s[28:31], s41 offen sc1
    buffer_load_dwordx4 v[52:55], v70, s[28:31], s41 offen sc1
    buffer_load_dwordx4 v[56:59], v71, s[28:31], s41 offen sc1
    buffer_load_dwordx4 v[60:63], v72, s[28:31], s41 offen sc1
    s_add_u32 s51, s51, 1
    s_cmp_lt_u32 s51, 400000
    s_cbranch_scc1 L_mp16
L_mpd17:
    s_mov_b64 exec, -1
    v_pk_add_f32 v[136:137], v[24:25], v[44:45]
    v_pk_add_f32 v[138:139], v[26:27], v[46:47]
    v_pk_add_f32 v[140:141], v[28:29], v[48:49]
    v_pk_add_f32 v[142:143], v[30:31], v[50:51]
    v_pk_add_f32 v[144:145], v[32:33], v[52:53]
    v_pk_add_f32 v[146:147], v[34:35], v[54:55]
    v_pk_add_f32 v[148:149], v[36:37], v[56:57]
    v_pk_add_f32 v[150:151], v[38:39], v[58:59]
    v_pk_add_f32 v[152:153], v[40:41], v[60:61]
    v_pk_add_f32 v[154:155], v[42:43], v[62:63]
L_mpj18:
    v_pk_add_f32 v[136:137], v[136:137], v[74:75] op_sel_hi:[1,0]
    v_pk_add_f32 v[138:139], v[138:139], v[74:75] op_sel_hi:[1,0]
    v_pk_add_f32 v[140:141], v[140:141], v[76:77] op_sel_hi:[1,0]
    v_pk_add_f32 v[142:143], v[142:143], v[76:77] op_sel_hi:[1,0]
    v_pk_add_f32 v[144:145], v[144:145], v[78:79] op_sel_hi:[1,0]
    v_pk_add_f32 v[146:147], v[146:147], v[78:79] op_sel_hi:[1,0]
    v_pk_add_f32 v[148:149], v[148:149], v[80:81] op_sel_hi:[1,0]
    v_pk_add_f32 v[150:151], v[150:151], v[80:81] op_sel_hi:[1,0]
    v_pk_add_f32 v[152:153], v[152:153], v[82:83] op_sel_hi:[1,0]
    v_pk_add_f32 v[154:155], v[154:155], v[82:83] op_sel_hi:[1,0]
    ds_write_b128 v68, v[136:139] offset:16640
    ds_write_b128 v69, v[140:143] offset:16640
    ds_write_b128 v70, v[144:147] offset:16640
    ds_write_b128 v71, v[148:151] offset:16640
    ds_write_b128 v72, v[152:155] offset:16640
L_imp_b4:
    s_waitcnt lgkmcnt(0)
    s_barrier
    s_cmp_eq_u32 s3, 0
    s_cbranch_scc1 L_imp_ln
    s_lshl_b32 s40, s3, 3
    s_or_b32 s40, s40, s4
    s_cmp_eq_u32 s40, 8
    s_cbranch_scc0 L_FINISH
    v_mov_b32 v58, 0
    s_mov_b64 exec, 1
    buffer_store_dword v93, v58, s[28:31], 0 offen sc1
    s_mov_b64 exec, -1
    s_branch L_FINISH
L_imp_ln:
    ds_read_b64 v[24:25], v58 offset:14080
    ds_read_b64 v[26:27], v58 offset:14088
    ds_read_b64 v[28:29], v58 offset:14096
    ds_read_b64 v[30:31], v58 offset:14104
    ds_read_b64 v[32:33], v58 offset:14112
    ds_read_b64 v[34:35], v58 offset:16640
    ds_read_b64 v[36:37], v58 offset:16648
    ds_read_b64 v[38:39], v58 offset:16656
    ds_read_b64 v[40:41], v58 offset:16664
    ds_read_b64 v[42:43], v58 offset:16672
    ds_read_b64 v[66:67], v58 offset:21760
    ds_read_b64 v[68:69], v58 offset:21768
    ds_read_b64 v[70:71], v58 offset:21776
    ds_read_b64 v[72:73], v58 offset:21784
    ds_read_b64 v[74:75], v58 offset:21792
    ds_read_b64 v[44:45], v58 offset:19200
    ds_read_b64 v[46:47], v58 offset:19208
    ds_read_b64 v[48:49], v58 offset:19216
    ds_read_b64 v[50:51], v58 offset:19224
    ds_read_b64 v[52:53], v58 offset:19232
    s_waitcnt lgkmcnt(10)
    v_pk_fma_f32 v[24:25], v[34:35], v[24:25], v[76:77]
    v_pk_fma_f32 v[26:27], v[36:37], v[26:27], v[78:79]
    v_pk_fma_f32 v[28:29], v[38:39], v[28:29], v[80:81]
    v_pk_fma_f32 v[30:31], v[40:41], v[30:31], v[82:83]
    v_pk_fma_f32 v[32:33], v[42:43], v[32:33], v[84:85]
    v_pk_add_f32 v[54:55], v[24:25], v[26:27]
    v_pk_mul_f32 v[56:57], v[24:25], v[24:25]
    v_pk_fma_f32 v[56:57], v[26:27], v[26:27], v[56:57]
    v_pk_add_f32 v[54:55], v[54:55], v[28:29]
    v_pk_fma_f32 v[56:57], v[28:29], v[28:29], v[56:57]
    v_pk_add_f32 v[54:55], v[54:55], v[30:31]
    v_pk_fma_f32 v[56:57], v[30:31], v[30:31], v[56:57]
    v_pk_add_f32 v[54:55], v[54:55], v[32:33]
    v_pk_fma_f32 v[56:57], v[32:33], v[32:33], v[56:57]
    v_add_f32 v54, v54, v55
    v_add_f32 v56, v56, v57
    s_nop 0
    v_add_f32_dpp v54, v54, v54 quad_perm:[1,0,3,2] row_mask:0xf bank_mask:0xf
    v_add_f32_dpp v56, v56, v56 quad_perm:[1,0,3,2] row_mask:0xf bank_mask:0xf
    v_mov_b32 v97, v24
    v_add_f32_dpp v54, v54, v54 quad_perm:[2,3,0,1] row_mask:0xf bank_mask:0xf
    v_add_f32_dpp v56, v56, v56 quad_perm:[2,3,0,1] row_mask:0xf bank_mask:0xf
    v_mov_b32 v101, v25
    v_add_f32_dpp v54, v54, v54 row_ror:4 row_mask:0xf bank_mask:0xf
    v_add_f32_dpp v56, v56, v56 row_ror:4 row_mask:0xf bank_mask:0xf
    v_mov_b32 v105, v26
    v_add_f32_dpp v54, v54, v54 row_ror:8 row_mask:0xf bank_mask:0xf
    v_add_f32_dpp v56, v56, v56 row_ror:8 row_mask:0xf bank_mask:0xf
    v_mov_b32 v109, v27
    v_mov_b32 v55, v54
    v_mov_b32 v57, v56
    v_mov_b32 v113, v28
    v_permlane16_swap_b32 v54, v55
    v_permlane16_swap_b32 v56, v57
    v_mov_b32 v117, v29
    v_add_f32 v54, v54, v55
    v_add_f32 v56, v56, v57
    v_mov_b32 v121, v30
    v_mov_b32 v55, v54
    v_mov_b32 v57, v56
    v_mov_b32 v125, v31
    v_permlane32_swap_b32 v54, v55
    v_permlane32_swap_b32 v56, v57
    v_mov_b32 v129, v32
    v_add_f32 v54, v54, v55
    v_add_f32 v56, v56, v57
    v_mov_b32 v133, v33
    v_mul_f32 v54, 0x3acccccd, v54
    v_mul_f32 v56, 0x3acccccd, v56
    v_fma_f32 v56, -v54, v54, v56
    v_max_f32 v56, 0, v56
    v_add_f32 v56, 0x3727c5ac, v56
    v_rsq_f32 v55, v56
    s_nop 0
    v_mul_f32 v56, v54, v55
    v_mov_b32 v54, v55
    s_waitcnt lgkmcnt(0)
    v_pk_fma_f32 v[24:25], v[24:25], v[54:55], v[56:57] op_sel_hi:[1,0,0] neg_lo:[0,0,1] neg_hi:[0,0,1]
    v_pk_fma_f32 v[26:27], v[26:27], v[54:55], v[56:57] op_sel_hi:[1,0,0] neg_lo:[0,0,1] neg_hi:[0,0,1]
    v_pk_fma_f32 v[28:29], v[28:29], v[54:55], v[56:57] op_sel_hi:[1,0,0] neg_lo:[0,0,1] neg_hi:[0,0,1]
    v_pk_fma_f32 v[30:31], v[30:31], v[54:55], v[56:57] op_sel_hi:[1,0,0] neg_lo:[0,0,1] neg_hi:[0,0,1]
    v_pk_fma_f32 v[32:33], v[32:33], v[54:55], v[56:57] op_sel_hi:[1,0,0] neg_lo:[0,0,1] neg_hi:[0,0,1]
    v_pk_fma_f32 v[24:25], v[24:25], v[66:67], v[44:45]
    v_pk_fma_f32 v[26:27], v[26:27], v[68:69], v[46:47]
    v_pk_fma_f32 v[28:29], v[28:29], v[70:71], v[48:49]
    v_pk_fma_f32 v[30:31], v[30:31], v[72:73], v[50:51]
    v_pk_fma_f32 v[32:33], v[32:33], v[74:75], v[52:53]
    v_pk_add_f32 v[54:55], v[24:25], v[26:27]
    v_pk_mul_f32 v[56:57], v[24:25], v[24:25]
    v_pk_fma_f32 v[56:57], v[26:27], v[26:27], v[56:57]
    v_pk_add_f32 v[54:55], v[54:55], v[28:29]
    v_pk_fma_f32 v[56:57], v[28:29], v[28:29], v[56:57]
    v_pk_add_f32 v[54:55], v[54:55], v[30:31]
    v_pk_fma_f32 v[56:57], v[30:31], v[30:31], v[56:57]
    v_pk_add_f32 v[54:55], v[54:55], v[32:33]
    v_pk_fma_f32 v[56:57], v[32:33], v[32:33], v[56:57]
    v_add_f32 v54, v54, v55
    v_add_f32 v56, v56, v57
    s_nop 0
    v_add_f32_dpp v54, v54, v54 quad_perm:[1,0,3,2] row_mask:0xf bank_mask:0xf
    v_add_f32_dpp v56, v56, v56 quad_perm:[1,0,3,2] row_mask:0xf bank_mask:0xf
    ds_read_b32 v98, v58 offset:24320
    v_add_f32_dpp v54, v54, v54 quad_perm:[2,3,0,1] row_mask:0xf bank_mask:0xf
    v_add_f32_dpp v56, v56, v56 quad_perm:[2,3,0,1] row_mask:0xf bank_mask:0xf
    ds_read_b32 v102, v58 offset:24324
    v_add_f32_dpp v54, v54, v54 row_ror:4 row_mask:0xf bank_mask:0xf
    v_add_f32_dpp v56, v56, v56 row_ror:4 row_mask:0xf bank_mask:0xf
    ds_read_b32 v106, v58 offset:24328
    v_add_f32_dpp v54, v54, v54 row_ror:8 row_mask:0xf bank_mask:0xf
    v_add_f32_dpp v56, v56, v56 row_ror:8 row_mask:0xf bank_mask:0xf
    ds_read_b32 v110, v58 offset:24332
    v_mov_b32 v55, v54
    v_mov_b32 v57, v56
    ds_read_b32 v114, v58 offset:24336
    v_permlane16_swap_b32 v54, v55
    v_permlane16_swap_b32 v56, v57
    ds_read_b32 v118, v58 offset:24340
    v_add_f32 v54, v54, v55
    v_add_f32 v56, v56, v57
    ds_read_b32 v122, v58 offset:24344
    v_mov_b32 v55, v54
    v_mov_b32 v57, v56
    ds_read_b32 v126, v58 offset:24348
    v_permlane32_swap_b32 v54, v55
    v_permlane32_swap_b32 v56, v57
    ds_read_b32 v130, v58 offset:24352
    v_add_f32 v54, v54, v55
    v_add_f32 v56, v56, v57
    ds_read_b32 v134, v58 offset:24356
    v_mul_f32 v54, 0x3acccccd, v54
    v_mul_f32 v56, 0x3acccccd, v56
    v_fma_f32 v56, -v54, v54, v56
    v_max_f32 v56, 0, v56
    v_add_f32 v56, 0x3727c5ac, v56
    v_rsq_f32 v55, v56
    s_nop 0
    v_mul_f32 v56, v54, v55
    v_mov_b32 v54, v55
    v_fma_f32 v96, v24, v54, -v56
    v_fma_f32 v100, v25, v54, -v56
    v_fma_f32 v104, v26, v54, -v56
    v_fma_f32 v108, v27, v54, -v56
    v_fma_f32 v112, v28, v54, -v56
    v_fma_f32 v116, v29, v54, -v56
    v_fma_f32 v120, v30, v54, -v56
    v_fma_f32 v124, v31, v54, -v56
    v_fma_f32 v128, v32, v54, -v56
    v_fma_f32 v132, v33, v54, -v56
    s_waitcnt lgkmcnt(0)
    s_mov_b64 exec, s[42:43]
    s_cmp_eq_u32 s10, 1
    s_cbranch_scc0 L_sl19
    buffer_store_dwordx4 v[96:99], v59, s[28:31], s46 offen offset:0
    buffer_store_dwordx4 v[100:103], v59, s[28:31], s46 offen offset:128
    buffer_store_dwordx4 v[104:107], v59, s[28:31], s46 offen offset:256
    buffer_store_dwordx4 v[108:111], v59, s[28:31], s46 offen offset:384
    buffer_store_dwordx4 v[112:115], v59, s[28:31], s46 offen offset:512
    buffer_store_dwordx4 v[116:119], v59, s[28:31], s46 offen offset:640
    buffer_store_dwordx4 v[120:123], v59, s[28:31], s46 offen offset:768
    buffer_store_dwordx4 v[124:127], v59, s[28:31], s46 offen offset:896
    buffer_store_dwordx4 v[128:131], v59, s[28:31], s46 offen offset:1024
    buffer_store_dwordx4 v[132:135], v59, s[28:31], s46 offen offset:1152
L_sd20:
    s_mov_b64 exec, -1
    s_branch L_FINISH
L_Q2:
    v_and_b32 v148, 7, v0
    v_lshrrev_b32 v149, 1, v148
    v_and_b32 v148, 1, v148
    v_mov_b32 v150, 0xffff
    v_mov_b32 v151, 0xffff0000
    v_cmp_eq_u32 vcc, 1, v148
    v_cmp_eq_u32 s[32:33], 0, v149
    v_cmp_eq_u32 s[34:35], 1, v149
    v_cmp_eq_u32 s[36:37], 2, v149
    v_cmp_eq_u32 s[38:39], 3, v149
    v_cndmask_b32 v150, v150, v151, vcc
    v_cndmask_b32_e64 v4, 0, v150, s[32:33]
    v_cndmask_b32_e64 v5, 0, v150, s[34:35]
    v_cndmask_b32_e64 v6, 0, v150, s[36:37]
    v_cndmask_b32_e64 v7, 0, v150, s[38:39]
    s_getreg_b32 s45, hwreg(HW_REG_XCC_ID, 0, 4)
    s_waitcnt lgkmcnt(0)
    s_add_u32 s8, s8, 1
    s_and_b32 s9, s8, 0xff
    s_lshl_b32 s46, s8, 4
    s_or_b32 s47, s46, s45
    v_mov_b32 v163, s47
    s_lshl_b32 s48, s4, 12
    s_lshl_b32 s49, s5, 7
    s_add_u32 s48, s48, s49
    s_add_u32 s48, s48, 4096
    v_mov_b32 v9, 0
    s_mov_b64 exec, 1
    buffer_store_dword v163, v9, s[28:31], s48 offen sc1
    s_mov_b64 exec, -1
    v_mov_b32 v147, s8
    s_waitcnt vmcnt(20)
    v_lshlrev_b32 v132, 16, v142
    v_and_b32 v133, 0xffff0000, v142
    v_lshlrev_b32 v134, 16, v143
    v_and_b32 v135, 0xffff0000, v143
    v_lshlrev_b32 v136, 16, v144
    v_and_b32 v137, 0xffff0000, v144
    v_lshlrev_b32 v138, 16, v145
    v_and_b32 v139, 0xffff0000, v145
    v_lshlrev_b32 v140, 16, v146
    v_and_b32 v141, 0xffff0000, v146
    v_add_f32 v148, v132, v133
    v_add_f32 v148, v148, v134
    v_add_f32 v148, v148, v135
    v_add_f32 v148, v148, v136
    v_add_f32 v148, v148, v137
    v_add_f32 v148, v148, v138
    v_add_f32 v148, v148, v139
    v_add_f32 v148, v148, v140
    v_add_f32 v148, v148, v141
    s_nop 1
    v_add_f32_dpp v148, v148, v148 quad_perm:[1,0,3,2] row_mask:0xf bank_mask:0xf
    s_nop 1
    v_add_f32_dpp v148, v148, v148 quad_perm:[2,3,0,1] row_mask:0xf bank_mask:0xf
    s_nop 1
    v_add_f32_dpp v148, v148, v148 row_ror:4 row_mask:0xf bank_mask:0xf
    s_nop 1
    v_add_f32_dpp v148, v148, v148 row_ror:8 row_mask:0xf bank_mask:0xf
    v_mov_b32 v149, v148
    s_nop 1
    v_permlane16_swap_b32 v148, v149
    v_add_f32 v148, v148, v149
    v_mov_b32 v149, v148
    s_nop 1
    v_permlane32_swap_b32 v148, v149
    v_add_f32 v148, v148, v149
    v_mul_f32 v148, 0x3acccccd, v148
    v_sub_f32 v149, v132, v148
    v_mul_f32 v150, v149, v149
    v_sub_f32 v149, v133, v148
    v_fmac_f32 v150, v149, v149
    v_sub_f32 v149, v134, v148
    v_fmac_f32 v150, v149, v149
    v_sub_f32 v149, v135, v148
    v_fmac_f32 v150, v149, v149
    v_sub_f32 v149, v136, v148
    v_fmac_f32 v150, v149, v149
    v_sub_f32 v149, v137, v148
    v_fmac_f32 v150, v149, v149
    v_sub_f32 v149, v138, v148
    v_fmac_f32 v150, v149, v149
    v_sub_f32 v149, v139, v148
    v_fmac_f32 v150, v149, v149
    v_sub_f32 v149, v140, v148
    v_fmac_f32 v150, v149, v149
    v_sub_f32 v149, v141, v148
    v_fmac_f32 v150, v149, v149
    s_nop 1
    v_add_f32_dpp v150, v150, v150 quad_perm:[1,0,3,2] row_mask:0xf bank_mask:0xf
    s_nop 1
    v_add_f32_dpp v150, v150, v150 quad_perm:[2,3,0,1] row_mask:0xf bank_mask:0xf
    s_nop 1
    v_add_f32_dpp v150, v150, v150 row_ror:4 row_mask:0xf bank_mask:0xf
    s_nop 1
    v_add_f32_dpp v150, v150, v150 row_ror:8 row_mask:0xf bank_mask:0xf
    v_mov_b32 v149, v150
    s_nop 1
    v_permlane16_swap_b32 v150, v149
    v_add_f32 v150, v150, v149
    v_mov_b32 v149, v150
    s_nop 1
    v_permlane32_swap_b32 v150, v149
    v_add_f32 v150, v150, v149
    v_mul_f32 v150, 0x3acccccd, v150
    v_cvt_pk_bf16_f32 v149, v148, v150
    v_lshlrev_b32 v148, 16, v149
    v_and_b32 v150, 0xffff0000, v149
    v_add_f32 v150, 0x3727c5ac, v150
    v_cvt_pk_bf16_f32 v149, v150, v150
    v_lshlrev_b32 v150, 16, v149
    v_sqrt_f32 v150, v150
    s_nop 0
    v_cvt_pk_bf16_f32 v149, v150, v150
    v_lshlrev_b32 v150, 16, v149
    v_rcp_f32 v151, v150
    v_lshlrev_b32 v48, 16, v164
    v_and_b32 v49, 0xffff0000, v164
    v_lshlrev_b32 v50, 16, v165
    v_and_b32 v51, 0xffff0000, v165
    v_sub_f32 v48, v48, v148
    v_sub_f32 v49, v49, v148
    v_sub_f32 v50, v50, v148
    v_sub_f32 v51, v51, v148
    v_cvt_pk_bf16_f32 v149, v48, v49
    v_lshlrev_b32 v48, 16, v149
    v_and_b32 v49, 0xffff0000, v149
    v_cvt_pk_bf16_f32 v149, v50, v51
    v_lshlrev_b32 v50, 16, v149
    v_and_b32 v51, 0xffff0000, v149
    v_mul_f32 v152, v48, v151
    v_fma_f32 v153, -v152, v150, v48
    v_fma_f32 v48, v153, v151, v152
    v_mul_f32 v152, v49, v151
    v_fma_f32 v153, -v152, v150, v49
    v_fma_f32 v49, v153, v151, v152
    v_mul_f32 v152, v50, v151
    v_fma_f32 v153, -v152, v150, v50
    v_fma_f32 v50, v153, v151, v152
    v_mul_f32 v152, v51, v151
    v_fma_f32 v153, -v152, v150, v51
    v_fma_f32 v51, v153, v151, v152
    v_cvt_pk_bf16_f32 v149, v48, v49
    v_lshlrev_b32 v48, 16, v149
    v_and_b32 v49, 0xffff0000, v149
    v_cvt_pk_bf16_f32 v149, v50, v51
    v_lshlrev_b32 v50, 16, v149
    v_and_b32 v51, 0xffff0000, v149
    v_min_u32 v8, 39, v0
    s_mul_i32 s42, s7, 20
    v_add_u32 v9, s42, v8
    v_cmp_lt_u32 vcc, 19, v8
    v_add_u32 v10, 140, v9
    s_nop 0
    v_cndmask_b32 v9, v9, v10, vcc
    v_lshlrev_b32 v10, 3, v9
    v_add_u32 v10, 5120, v10
    v_lshlrev_b32 v9, 4, v9
    v_and_b32 v8, 31, v0
    v_lshlrev_b32 v8, 7, v8
    s_lshl_b32 s42, s4, 12
    s_add_u32 s42, s42, 4096
    s_mov_b32 s32, 40960
    s_mov_b32 s33, 48640
    s_mov_b32 s34, 56320
    s_mov_b32 s35, 64000
    s_and_b32 s43, s8, 0x0fffffff
    s_waitcnt vmcnt(0)
    s_mov_b32 exec_lo, 0xffffffff
    s_mov_b32 exec_hi, 0xff
    s_mov_b32 s51, 0
    buffer_load_dword v160, v8, s[28:31], s42 offen sc1
    buffer_load_dwordx4 v[12:15], v9, s[28:31], s32 offen sc1
    buffer_load_dwordx2 v[16:17], v10, s[28:31], s32 offen sc1
    buffer_load_dwordx4 v[18:21], v9, s[28:31], s33 offen sc1
    buffer_load_dwordx2 v[22:23], v10, s[28:31], s33 offen sc1
    buffer_load_dwordx4 v[24:27], v9, s[28:31], s34 offen sc1
    buffer_load_dwordx2 v[28:29], v10, s[28:31], s34 offen sc1
    buffer_load_dwordx4 v[30:33], v9, s[28:31], s35 offen sc1
    buffer_load_dwordx2 v[34:35], v10, s[28:31], s35 offen sc1
L_pp21:
    s_waitcnt vmcnt(0)
    v_lshrrev_b32 v132, 4, v160
    v_xor_b32 v132, s43, v132
    v_bitop3_b32 v133, v15, v17, v147 bitop3:0x7e
    v_or_b32 v132, v132, v133
    v_bitop3_b32 v133, v21, v23, v147 bitop3:0x7e
    v_or_b32 v132, v132, v133
    v_bitop3_b32 v133, v27, v29, v147 bitop3:0x7e
    v_or_b32 v132, v132, v133
    v_bitop3_b32 v133, v33, v35, v147 bitop3:0x7e
    v_or_b32 v132, v132, v133
    v_cmp_ne_u32 vcc, 0, v132
    s_cmp_eq_u64 vcc, 0
    s_cbranch_scc1 L_ppd22
    buffer_load_dword v160, v8, s[28:31], s42 offen sc1
    buffer_load_dwordx4 v[12:15], v9, s[28:31], s32 offen sc1
    buffer_load_dwordx2 v[16:17], v10, s[28:31], s32 offen sc1
    buffer_load_dwordx4 v[18:21], v9, s[28:31], s33 offen sc1
    buffer_load_dwordx2 v[22:23], v10, s[28:31], s33 offen sc1
    buffer_load_dwordx4 v[24:27], v9, s[28:31], s34 offen sc1
    buffer_load_dwordx2 v[28:29], v10, s[28:31], s34 offen sc1
    buffer_load_dwordx4 v[30:33], v9, s[28:31], s35 offen sc1
    buffer_load_dwordx2 v[34:35], v10, s[28:31], s35 offen sc1
    s_add_u32 s51, s51, 1
    s_cmp_lt_u32 s51, 400000
    s_cbranch_scc1 L_pp21
L_ppd22:
    v_add_f32 v136, v12, v18
    v_add_f32 v136, v136, v24
    v_add_f32 v136, v136, v30
    v_add_f32 v137, v13, v19
    v_add_f32 v137, v137, v25
    v_add_f32 v137, v137, v31
    v_add_f32 v138, v14, v20
    v_add_f32 v138, v138, v26
    v_add_f32 v138, v138, v32
    v_add_f32 v139, v16, v22
    v_add_f32 v139, v139, v28
    v_add_f32 v139, v139, v34
    v_mov_b32 v140, v160
L_ppj23:
    s_mov_b64 exec, -1
    s_mov_b32 exec_lo, 0xffffffff
    s_mov_b32 exec_hi, 0x0
    v_cmp_ne_u32 vcc, s47, v140
    s_mov_b64 exec, -1
    s_cmp_eq_u64 vcc, 0
    s_cselect_b32 s10, 1, 0
    v_cvt_pk_bf16_f32 v132, v136, v137
    v_lshlrev_b32 v136, 16, v132
    v_and_b32 v137, 0xffff0000, v132
    v_cvt_pk_bf16_f32 v132, v138, v139
    v_lshlrev_b32 v138, 16, v132
    v_and_b32 v139, 0xffff0000, v132
    v_add_u32 v8, 20, v0
    v_lshlrev_b32 v8, 2, v8
    ds_bpermute_b32 v140, v8, v136
    ds_bpermute_b32 v141, v8, v137
    ds_bpermute_b32 v142, v8, v138
    ds_bpermute_b32 v143, v8, v139
    v_mov_b32 v144, s10
    v_mov_b32 v145, 0
    s_mov_b64 exec, 1
    ds_write_b32 v145, v144 offset:3200
    s_mov_b64 exec, -1
    v_lshlrev_b32 v146, 4, v0
    v_lshlrev_b32 v36, 2, v3
    v_add_u32 v36, 2560, v36
    s_waitcnt lgkmcnt(0)
    v_add_f32 v140, 1.0, v140
    v_add_f32 v141, 1.0, v141
    v_add_f32 v142, 1.0, v142
    v_add_f32 v143, 1.0, v143
    v_cvt_pk_bf16_f32 v132, v140, v141
    v_lshlrev_b32 v140, 16, v132
    v_and_b32 v141, 0xffff0000, v132
    v_cvt_pk_bf16_f32 v132, v142, v143
    v_lshlrev_b32 v142, 16, v132
    v_and_b32 v143, 0xffff0000, v132
    v_mul_f32 v140, v48, v140
    v_mul_f32 v141, v49, v141
    v_mul_f32 v142, v50, v142
    v_mul_f32 v143, v51, v143
    v_cvt_pk_bf16_f32 v132, v140, v141
    v_lshlrev_b32 v140, 16, v132
    v_and_b32 v141, 0xffff0000, v132
    v_cvt_pk_bf16_f32 v132, v142, v143
    v_lshlrev_b32 v142, 16, v132
    v_and_b32 v143, 0xffff0000, v132
    v_add_f32 v140, v140, v136
    v_add_f32 v141, v141, v137
    v_add_f32 v142, v142, v138
    v_add_f32 v143, v143, v139
    v_cvt_pk_bf16_f32 v140, v140, v140
    v_cvt_pk_bf16_f32 v141, v141, v141
    v_cvt_pk_bf16_f32 v142, v142, v142
    v_cvt_pk_bf16_f32 v143, v143, v143
    s_mov_b32 exec_lo, 0xfffff
    s_mov_b32 exec_hi, 0x0
    ds_write_b128 v146, v[140:143] offset:2560
    s_mov_b64 exec, -1
    s_waitcnt lgkmcnt(0)
    ds_read2_b32 v[132:133], v36 offset0:0 offset1:4
    ds_read2_b32 v[134:135], v36 offset0:8 offset1:12
    ds_read2_b32 v[136:137], v36 offset0:16 offset1:20
    ds_read2_b32 v[138:139], v36 offset0:24 offset1:28
    ds_read2_b32 v[140:141], v36 offset0:32 offset1:36
    ds_read2_b32 v[142:143], v36 offset0:40 offset1:44
    ds_read2_b32 v[144:145], v36 offset0:48 offset1:52
    ds_read2_b32 v[48:49], v36 offset0:56 offset1:60
    ds_read2_b32 v[50:51], v36 offset0:64 offset1:68
    ds_read2_b32 v[164:165], v36 offset0:72 offset1:76
    v_lshl_add_u32 v8, v2, 1, v3
    v_lshlrev_b32 v11, 3, v8
    v_lshlrev_b32 v8, 4, v8
    s_lshl_b32 s42, s6, 3
    s_add_u32 s43, s42, s7
    s_mul_i32 s43, s43, 768
    s_add_u32 s43, s43, 81920
    s_waitcnt lgkmcnt(0)
    v_and_b32 v148, v132, v4
    v_and_b32 v149, v132, v5
    v_and_b32 v150, v132, v6
    v_and_b32 v151, v132, v7
    s_nop 1
    v_mfma_f32_16x16x32_bf16 v[156:159], v[148:151], v[52:55], 0
    v_and_b32 v152, v133, v4
    v_and_b32 v153, v133, v5
    v_and_b32 v154, v133, v6
    v_and_b32 v155, v133, v7
    s_nop 1
    v_mfma_f32_16x16x32_bf16 v[156:159], v[152:155], v[56:59], v[156:159]
    v_and_b32 v148, v134, v4
    v_and_b32 v149, v134, v5
    v_and_b32 v150, v134, v6
    v_and_b32 v151, v134, v7
    s_nop 1
    v_mfma_f32_16x16x32_bf16 v[156:159], v[148:151], v[60:63], v[156:159]
    v_and_b32 v152, v135, v4
    v_and_b32 v153, v135, v5
    v_and_b32 v154, v135, v6
    v_and_b32 v155, v135, v7
    s_nop 1
    v_mfma_f32_16x16x32_bf16 v[156:159], v[152:155], v[64:67], v[156:159]
    v_and_b32 v148, v136, v4
    v_and_b32 v149, v136, v5
    v_and_b32 v150, v136, v6
    v_and_b32 v151, v136, v7
    s_nop 1
    v_mfma_f32_16x16x32_bf16 v[156:159], v[148:151], v[68:71], v[156:159]
    v_and_b32 v152, v137, v4
    v_and_b32 v153, v137, v5
    v_and_b32 v154, v137, v6
    v_and_b32 v155, v137, v7
    s_nop 1
    v_mfma_f32_16x16x32_bf16 v[156:159], v[152:155], v[72:75], v[156:159]
    v_and_b32 v148, v138, v4
    v_and_b32 v149, v138, v5
    v_and_b32 v150, v138, v6
    v_and_b32 v151, v138, v7
    s_nop 1
    v_mfma_f32_16x16x32_bf16 v[156:159], v[148:151], v[76:79], v[156:159]
    v_and_b32 v152, v139, v4
    v_and_b32 v153, v139, v5
    v_and_b32 v154, v139, v6
    v_and_b32 v155, v139, v7
    s_nop 1
    v_mfma_f32_16x16x32_bf16 v[156:159], v[152:155], v[80:83], v[156:159]
    v_and_b32 v148, v140, v4
    v_and_b32 v149, v140, v5
    v_and_b32 v150, v140, v6
    v_and_b32 v151, v140, v7
    s_nop 1
    v_mfma_f32_16x16x32_bf16 v[156:159], v[148:151], v[84:87], v[156:159]
    v_and_b32 v152, v141, v4
    v_and_b32 v153, v141, v5
    v_and_b32 v154, v141, v6
    v_and_b32 v155, v141, v7
    s_nop 1
    v_mfma_f32_16x16x32_bf16 v[156:159], v[152:155], v[88:91], v[156:159]
    v_and_b32 v148, v142, v4
    v_and_b32 v149, v142, v5
    v_and_b32 v150, v142, v6
    v_and_b32 v151, v142, v7
    s_nop 1
    v_mfma_f32_16x16x32_bf16 v[156:159], v[148:151], v[92:95], v[156:159]
    v_and_b32 v152, v143, v4
    v_and_b32 v153, v143, v5
    v_and_b32 v154, v143, v6
    v_and_b32 v155, v143, v7
    s_nop 1
    v_mfma_f32_16x16x32_bf16 v[156:159], v[152:155], v[96:99], v[156:159]
    v_and_b32 v148, v144, v4
    v_and_b32 v149, v144, v5
    v_and_b32 v150, v144, v6
    v_and_b32 v151, v144, v7
    s_nop 1
    v_mfma_f32_16x16x32_bf16 v[156:159], v[148:151], v[100:103], v[156:159]
    v_and_b32 v152, v145, v4
    v_and_b32 v153, v145, v5
    v_and_b32 v154, v145, v6
    v_and_b32 v155, v145, v7
    s_nop 1
    v_mfma_f32_16x16x32_bf16 v[156:159], v[152:155], v[104:107], v[156:159]
    v_and_b32 v148, v48, v4
    v_and_b32 v149, v48, v5
    v_and_b32 v150, v48, v6
    v_and_b32 v151, v48, v7
    s_nop 1
    v_mfma_f32_16x16x32_bf16 v[156:159], v[148:151], v[108:111], v[156:159]
    v_and_b32 v152, v49, v4
    v_and_b32 v153, v49, v5
    v_and_b32 v154, v49, v6
    v_and_b32 v155, v49, v7
    s_nop 1
    v_mfma_f32_16x16x32_bf16 v[156:159], v[152:155], v[112:115], v[156:159]
    v_and_b32 v148, v50, v4
    v_and_b32 v149, v50, v5
    v_and_b32 v150, v50, v6
    v_and_b32 v151, v50, v7
    s_nop 1
    v_mfma_f32_16x16x32_bf16 v[156:159], v[148:151], v[116:119], v[156:159]
    v_and_b32 v152, v51, v4
    v_and_b32 v153, v51, v5
    v_and_b32 v154, v51, v6
    v_and_b32 v155, v51, v7
    s_nop 1
    v_mfma_f32_16x16x32_bf16 v[156:159], v[152:155], v[120:123], v[156:159]
    v_and_b32 v148, v164, v4
    v_and_b32 v149, v164, v5
    v_and_b32 v150, v164, v6
    v_and_b32 v151, v164, v7
    s_nop 1
    v_mfma_f32_16x16x32_bf16 v[156:159], v[148:151], v[124:127], v[156:159]
    v_and_b32 v152, v165, v4
    v_and_b32 v153, v165, v5
    v_and_b32 v154, v165, v6
    v_and_b32 v155, v165, v7
    s_nop 1
    v_mfma_f32_16x16x32_bf16 v[156:159], v[152:155], v[128:131], v[156:159]
    v_mov_b32 v135, v147
    v_mov_b32 v137, v147
    v_and_b32 v146, 31, v0
    v_lshrrev_b32 v138, 5, v0
    s_movk_i32 s44, 3072
    v_lshlrev_b32 v9, 4, v146
    v_mad_u32_u24 v9, v138, s44, v9
    v_lshlrev_b32 v10, 3, v146
    v_mad_u32_u24 v10, v138, s44, v10
    s_mul_i32 s42, s42, 768
    s_add_u32 s42, s42, 81920
    v_mov_b32 v132, v156
    v_mov_b32 v133, v157
    v_mov_b32 v134, v158
    v_mov_b32 v136, v159
    s_mov_b32 exec_lo, 0xffffffff
    s_mov_b32 exec_hi, 0x0
    s_cmp_eq_u32 s10, 1
    s_cbranch_scc0 L_sl24
    buffer_store_dwordx4 v[132:135], v8, s[28:31], s43 offen
    buffer_store_dwordx2 v[136:137], v11, s[28:31], s43 offen offset:512
L_sd25:
    s_mov_b64 exec, -1
    s_waitcnt vmcnt(0)
    s_mov_b32 s51, 0
    buffer_load_dwordx4 v[52:55], v9, s[28:31], s42 offen offset:0 sc1
    buffer_load_dwordx2 v[56:57], v10, s[28:31], s42 offen offset:512 sc1
    buffer_load_dwordx4 v[58:61], v9, s[28:31], s42 offen offset:768 sc1
    buffer_load_dwordx2 v[62:63], v10, s[28:31], s42 offen offset:1280 sc1
    buffer_load_dwordx4 v[64:67], v9, s[28:31], s42 offen offset:1536 sc1
    buffer_load_dwordx2 v[68:69], v10, s[28:31], s42 offen offset:2048 sc1
    buffer_load_dwordx4 v[70:73], v9, s[28:31], s42 offen offset:2304 sc1
    buffer_load_dwordx2 v[74:75], v10, s[28:31], s42 offen offset:2816 sc1
L_pp26:
    s_waitcnt vmcnt(0)
    v_bitop3_b32 v138, v55, v57, v147 bitop3:0x7e
    v_bitop3_b32 v139, v61, v63, v147 bitop3:0x7e
    v_bitop3_b32 v140, v67, v69, v147 bitop3:0x7e
    v_bitop3_b32 v141, v73, v75, v147 bitop3:0x7e
    v_or3_b32 v138, v138, v139, v140
    v_or_b32 v138, v138, v141
    v_cmp_ne_u32 vcc, 0, v138
    s_cmp_eq_u64 vcc, 0
    s_cbranch_scc1 L_ppd27
    buffer_load_dwordx4 v[52:55], v9, s[28:31], s42 offen offset:0 sc1
    buffer_load_dwordx2 v[56:57], v10, s[28:31], s42 offen offset:512 sc1
    buffer_load_dwordx4 v[58:61], v9, s[28:31], s42 offen offset:768 sc1
    buffer_load_dwordx2 v[62:63], v10, s[28:31], s42 offen offset:1280 sc1
    buffer_load_dwordx4 v[64:67], v9, s[28:31], s42 offen offset:1536 sc1
    buffer_load_dwordx2 v[68:69], v10, s[28:31], s42 offen offset:2048 sc1
    buffer_load_dwordx4 v[70:73], v9, s[28:31], s42 offen offset:2304 sc1
    buffer_load_dwordx2 v[74:75], v10, s[28:31], s42 offen offset:2816 sc1
    s_add_u32 s51, s51, 1
    s_cmp_lt_u32 s51, 400000
    s_cbranch_scc1 L_pp26
L_ppd27:
    v_add_f32 v138, v52, v58
    v_add_f32 v142, v64, v70
    v_add_f32 v139, v53, v59
    v_add_f32 v143, v65, v71
    v_add_f32 v140, v54, v60
    v_add_f32 v144, v66, v72
    v_add_f32 v141, v56, v62
    v_add_f32 v145, v68, v74
L_ppj28:
    v_add_f32 v138, v138, v142
    v_add_f32 v139, v139, v143
    v_add_f32 v140, v140, v144
    v_add_f32 v141, v141, v145
    v_mov_b32 v142, v138
    v_mov_b32 v143, v139
    v_mov_b32 v144, v140
    v_mov_b32 v145, v141
    v_permlane32_swap_b32 v138, v142
    v_permlane32_swap_b32 v139, v143
    v_permlane32_swap_b32 v140, v144
    v_permlane32_swap_b32 v141, v145
    v_add_f32 v138, v138, v142
    v_add_f32 v139, v139, v143
    v_add_f32 v140, v140, v144
    v_add_f32 v141, v141, v145
    v_cvt_pk_bf16_f32 v142, v138, v139
    v_cvt_pk_bf16_f32 v143, v140, v141
    v_lshlrev_b32 v146, 3, v146
    v_mov_b32 v144, 0
    v_mov_b32 v145, 0
    v_mov_b32 v8, 0
    s_mov_b32 exec_lo, 0xffffffff
    s_mov_b32 exec_hi, 0x0
    ds_write_b64 v146, v[142:143] offset:2880
    s_mov_b64 exec, 1
    ds_write_b64 v8, v[144:145] offset:3216
    ds_write_b64 v8, v[144:145] offset:3224
    s_mov_b64 exec, -1
    s_waitcnt lgkmcnt(0)
    s_barrier
    s_branch L_FINISH
L_M2:
    v_and_b32 v148, 7, v0
    v_lshrrev_b32 v149, 1, v148
    v_and_b32 v148, 1, v148
    v_mov_b32 v150, 0xffff
    v_mov_b32 v151, 0xffff0000
    v_cmp_eq_u32 vcc, 1, v148
    v_cmp_eq_u32 s[32:33], 0, v149
    v_cmp_eq_u32 s[34:35], 1, v149
    v_cmp_eq_u32 s[36:37], 2, v149
    v_cmp_eq_u32 s[38:39], 3, v149
    v_cndmask_b32 v150, v150, v151, vcc
    v_cndmask_b32_e64 v4, 0, v150, s[32:33]
    v_cndmask_b32_e64 v5, 0, v150, s[34:35]
    v_cndmask_b32_e64 v6, 0, v150, s[36:37]
    v_cndmask_b32_e64 v7, 0, v150, s[38:39]
    v_lshlrev_b32 v9, 4, v0
    s_mul_i32 s42, s99, 640
    v_add_u32 v9, s42, v9
    v_bfe_u32 v8, v0, 3, 1
    v_lshl_add_u32 v8, v8, 2, v3
    v_lshlrev_b32 v8, 2, v8
    v_add_u32 v8, s42, v8
    s_waitcnt vmcnt(20)
    v_lshlrev_b32 v132, 16, v156
    v_and_b32 v133, 0xffff0000, v156
    v_lshlrev_b32 v134, 16, v157
    v_and_b32 v135, 0xffff0000, v157
    v_mul_f32 v148, 0xbfb8aa3b, v132
    v_mul_f32 v152, 0xbfb8aa3b, v133
    v_exp_f32 v148, v148
    v_exp_f32 v152, v152
    v_add_f32 v148, 1.0, v148
    v_add_f32 v152, 1.0, v152
    v_rcp_f32 v149, v148
    v_rcp_f32 v153, v152
    v_mul_f32 v150, v132, v149
    v_mul_f32 v154, v133, v153
    v_fma_f32 v151, -v150, v148, v132
    v_fma_f32 v155, -v154, v152, v133
    v_fma_f32 v150, v151, v149, v150
    v_fma_f32 v154, v155, v153, v154
    v_cvt_pk_bf16_f32 v132, v150, v150
    v_cvt_pk_bf16_f32 v133, v154, v154
    v_mul_f32 v148, 0xbfb8aa3b, v134
    v_mul_f32 v152, 0xbfb8aa3b, v135
    v_exp_f32 v148, v148
    v_exp_f32 v152, v152
    v_add_f32 v148, 1.0, v148
    v_add_f32 v152, 1.0, v152
    v_rcp_f32 v149, v148
    v_rcp_f32 v153, v152
    v_mul_f32 v150, v134, v149
    v_mul_f32 v154, v135, v153
    v_fma_f32 v151, -v150, v148, v134
    v_fma_f32 v155, -v154, v152, v135
    v_fma_f32 v150, v151, v149, v150
    v_fma_f32 v154, v155, v153, v154
    v_cvt_pk_bf16_f32 v134, v150, v150
    v_cvt_pk_bf16_f32 v135, v154, v154
    s_mov_b32 exec_lo, 0xffffffff
    s_mov_b32 exec_hi, 0xff
    ds_write_b128 v9, v[132:135] offset:0
    s_mov_b64 exec, -1
    s_waitcnt lgkmcnt(0)
    ds_read2_b32 v[112:113], v8 offset0:0 offset1:8
    ds_read2_b32 v[114:115], v8 offset0:16 offset1:24
    ds_read2_b32 v[116:117], v8 offset0:32 offset1:40
    ds_read2_b32 v[118:119], v8 offset0:48 offset1:56
    ds_read2_b32 v[120:121], v8 offset0:64 offset1:72
    ds_read2_b32 v[122:123], v8 offset0:80 offset1:88
    ds_read2_b32 v[124:125], v8 offset0:96 offset1:104
    ds_read2_b32 v[126:127], v8 offset0:112 offset1:120
    ds_read2_b32 v[128:129], v8 offset0:128 offset1:136
    ds_read2_b32 v[130:131], v8 offset0:144 offset1:152
    s_waitcnt lgkmcnt(0)
    s_add_u32 s8, s8, 1
    s_and_b32 s9, s8, 0xff
    v_mov_b32 v147, s8
    v_lshrrev_b32 v9, 3, v2
    v_lshrrev_b32 v10, 1, v3
    v_cmp_eq_u32 s[42:43], v9, v10
    v_and_b32 v9, 7, v2
    v_and_b32 v10, 1, v3
    v_lshl_add_u32 v9, v9, 1, v10
    v_lshlrev_b32 v8, 4, v9
    v_lshlrev_b32 v9, 3, v9
    s_mul_i32 s44, s99, 7680
    s_add_u32 s44, s44, 40960
    s_lshl_b32 s45, s98, 7
    s_add_u32 s45, s45, s44
    s_add_u32 s45, s45, 5120
    s_lshl_b32 s40, s98, 8
    s_add_u32 s44, s44, s40
    v_and_b32 v148, v112, v4
    v_and_b32 v149, v112, v5
    v_and_b32 v150, v112, v6
    v_and_b32 v151, v112, v7
    s_waitcnt vmcnt(19)
    s_nop 0
    v_mfma_f32_16x16x32_bf16 v[156:159], v[148:151], v[12:15], 0
    v_and_b32 v152, v113, v4
    v_and_b32 v153, v113, v5
    v_and_b32 v154, v113, v6
    v_and_b32 v155, v113, v7
    s_waitcnt vmcnt(18)
    s_nop 0
    v_mfma_f32_16x16x32_bf16 v[156:159], v[152:155], v[16:19], v[156:159]
    v_and_b32 v148, v114, v4
    v_and_b32 v149, v114, v5
    v_and_b32 v150, v114, v6
    v_and_b32 v151, v114, v7
    s_waitcnt vmcnt(17)
    s_nop 0
    v_mfma_f32_16x16x32_bf16 v[156:159], v[148:151], v[20:23], v[156:159]
    v_and_b32 v152, v115, v4
    v_and_b32 v153, v115, v5
    v_and_b32 v154, v115, v6
    v_and_b32 v155, v115, v7
    s_waitcnt vmcnt(16)
    s_nop 0
    v_mfma_f32_16x16x32_bf16 v[156:159], v[152:155], v[24:27], v[156:159]
    v_and_b32 v148, v116, v4
    v_and_b32 v149, v116, v5
    v_and_b32 v150, v116, v6
    v_and_b32 v151, v116, v7
    s_waitcnt vmcnt(15)
    s_nop 0
    v_mfma_f32_16x16x32_bf16 v[156:159], v[148:151], v[28:31], v[156:159]
    v_and_b32 v152, v117, v4
    v_and_b32 v153, v117, v5
    v_and_b32 v154, v117, v6
    v_and_b32 v155, v117, v7
    s_waitcnt vmcnt(14)
    s_nop 0
    v_mfma_f32_16x16x32_bf16 v[156:159], v[152:155], v[32:35], v[156:159]
    v_and_b32 v148, v118, v4
    v_and_b32 v149, v118, v5
    v_and_b32 v150, v118, v6
    v_and_b32 v151, v118, v7
    s_waitcnt vmcnt(13)
    s_nop 0
    v_mfma_f32_16x16x32_bf16 v[156:159], v[148:151], v[36:39], v[156:159]
    v_and_b32 v152, v119, v4
    v_and_b32 v153, v119, v5
    v_and_b32 v154, v119, v6
    v_and_b32 v155, v119, v7
    s_waitcnt vmcnt(12)
    s_nop 0
    v_mfma_f32_16x16x32_bf16 v[156:159], v[152:155], v[40:43], v[156:159]
    v_and_b32 v148, v120, v4
    v_and_b32 v149, v120, v5
    v_and_b32 v150, v120, v6
    v_and_b32 v151, v120, v7
    s_waitcnt vmcnt(11)
    s_nop 0
    v_mfma_f32_16x16x32_bf16 v[156:159], v[148:151], v[44:47], v[156:159]
    v_and_b32 v152, v121, v4
    v_and_b32 v153, v121, v5
    v_and_b32 v154, v121, v6
    v_and_b32 v155, v121, v7
    s_waitcnt vmcnt(10)
    s_nop 0
    v_mfma_f32_16x16x32_bf16 v[156:159], v[152:155], v[48:51], v[156:159]
    v_and_b32 v148, v122, v4
    v_and_b32 v149, v122, v5
    v_and_b32 v150, v122, v6
    v_and_b32 v151, v122, v7
    s_waitcnt vmcnt(9)
    s_nop 0
    v_mfma_f32_16x16x32_bf16 v[156:159], v[148:151], v[52:55], v[156:159]
    v_and_b32 v152, v123, v4
    v_and_b32 v153, v123, v5
    v_and_b32 v154, v123, v6
    v_and_b32 v155, v123, v7
    s_waitcnt vmcnt(8)
    s_nop 0
    v_mfma_f32_16x16x32_bf16 v[156:159], v[152:155], v[56:59], v[156:159]
    v_and_b32 v148, v124, v4
    v_and_b32 v149, v124, v5
    v_and_b32 v150, v124, v6
    v_and_b32 v151, v124, v7
    s_waitcnt vmcnt(7)
    s_nop 0
    v_mfma_f32_16x16x32_bf16 v[156:159], v[148:151], v[60:63], v[156:159]
    v_and_b32 v152, v125, v4
    v_and_b32 v153, v125, v5
    v_and_b32 v154, v125, v6
    v_and_b32 v155, v125, v7
    s_waitcnt vmcnt(6)
    s_nop 0
    v_mfma_f32_16x16x32_bf16 v[156:159], v[152:155], v[64:67], v[156:159]
    v_and_b32 v148, v126, v4
    v_and_b32 v149, v126, v5
    v_and_b32 v150, v126, v6
    v_and_b32 v151, v126, v7
    s_waitcnt vmcnt(5)
    s_nop 0
    v_mfma_f32_16x16x32_bf16 v[156:159], v[148:151], v[68:71], v[156:159]
    v_and_b32 v152, v127, v4
    v_and_b32 v153, v127, v5
    v_and_b32 v154, v127, v6
    v_and_b32 v155, v127, v7
    s_waitcnt vmcnt(4)
    s_nop 0
    v_mfma_f32_16x16x32_bf16 v[156:159], v[152:155], v[72:75], v[156:159]
    v_and_b32 v148, v128, v4
    v_and_b32 v149, v128, v5
    v_and_b32 v150, v128, v6
    v_and_b32 v151, v128, v7
    s_waitcnt vmcnt(3)
    s_nop 0
    v_mfma_f32_16x16x32_bf16 v[156:159], v[148:151], v[76:79], v[156:159]
    v_and_b32 v152, v129, v4
    v_and_b32 v153, v129, v5
    v_and_b32 v154, v129, v6
    v_and_b32 v155, v129, v7
    s_waitcnt vmcnt(2)
    s_nop 0
    v_mfma_f32_16x16x32_bf16 v[156:159], v[152:155], v[80:83], v[156:159]
    v_and_b32 v148, v130, v4
    v_and_b32 v149, v130, v5
    v_and_b32 v150, v130, v6
    v_and_b32 v151, v130, v7
    s_waitcnt vmcnt(1)
    s_nop 0
    v_mfma_f32_16x16x32_bf16 v[156:159], v[148:151], v[84:87], v[156:159]
    v_and_b32 v152, v131, v4
    v_and_b32 v153, v131, v5
    v_and_b32 v154, v131, v6
    v_and_b32 v155, v131, v7
    s_waitcnt vmcnt(0)
    s_nop 0
    v_mfma_f32_16x16x32_bf16 v[156:159], v[152:155], v[88:91], v[156:159]
    v_mov_b32 v137, v147
    s_nop 6
    v_cndmask_b32_e64 v132, 0, v156, s[42:43]
    v_cndmask_b32_e64 v133, 0, v157, s[42:43]
    v_cndmask_b32_e64 v134, 0, v158, s[42:43]
    v_cndmask_b32_e64 v135, 0, v159, s[42:43]
    v_add_f32_dpp v132, v132, v132 row_ror:8 row_mask:0xf bank_mask:0xf
    v_add_f32_dpp v133, v133, v133 row_ror:8 row_mask:0xf bank_mask:0xf
    v_add_f32_dpp v134, v134, v134 row_ror:8 row_mask:0xf bank_mask:0xf
    v_add_f32_dpp v135, v135, v135 row_ror:8 row_mask:0xf bank_mask:0xf
    v_mov_b32 v138, v132
    v_mov_b32 v139, v133
    v_mov_b32 v140, v134
    v_mov_b32 v141, v135
    v_permlane32_swap_b32 v132, v138
    v_permlane32_swap_b32 v133, v139
    v_permlane32_swap_b32 v134, v140
    v_permlane32_swap_b32 v135, v141
    v_add_f32 v132, v132, v138
    v_add_f32 v133, v133, v139
    v_add_f32 v134, v134, v140
    v_add_f32 v135, v135, v141
    v_mov_b32 v136, v135
    v_mov_b32 v135, v147
    s_mov_b32 exec_lo, 0xff00ff
    s_mov_b32 exec_hi, 0x0
    buffer_store_dwordx4 v[132:135], v8, s[28:31], s44 offen sc1
    buffer_store_dwordx2 v[136:137], v9, s[28:31], s45 offen sc1
    s_mov_b64 exec, -1
    s_branch L_FINISH
L_MGATE:
    v_mul_u32_u24 v8, 20, v0
    s_waitcnt lgkmcnt(0)
    s_load_dword s8, s[80:81], 0
    s_mov_b32 s28, s80
    s_and_b32 s29, s81, 0xffff
    global_load_dwordx4 v[156:159], v8, s[72:73]
    global_load_dword v160, v8, s[72:73] offset:16
    s_barrier
    s_barrier
    s_waitcnt vmcnt(0)
    v_lshlrev_b32 v132, 16, v156
    v_and_b32 v133, 0xffff0000, v156
    v_lshlrev_b32 v134, 16, v157
    v_and_b32 v135, 0xffff0000, v157
    v_lshlrev_b32 v136, 16, v158
    v_and_b32 v137, 0xffff0000, v158
    v_lshlrev_b32 v138, 16, v159
    v_and_b32 v139, 0xffff0000, v159
    v_lshlrev_b32 v140, 16, v160
    v_and_b32 v141, 0xffff0000, v160
    v_mul_f32 v148, 0xbfb8aa3b, v132
    v_mul_f32 v152, 0xbfb8aa3b, v133
    v_exp_f32 v148, v148
    v_exp_f32 v152, v152
    v_add_f32 v148, 1.0, v148
    v_add_f32 v152, 1.0, v152
    v_rcp_f32 v149, v148
    v_rcp_f32 v153, v152
    v_mul_f32 v150, v132, v149
    v_mul_f32 v154, v133, v153
    v_fma_f32 v151, -v150, v148, v132
    v_fma_f32 v155, -v154, v152, v133
    v_fma_f32 v150, v151, v149, v150
    v_fma_f32 v154, v155, v153, v154
    v_cvt_pk_bf16_f32 v132, v150, v150
    v_cvt_pk_bf16_f32 v133, v154, v154
    v_mul_f32 v148, 0xbfb8aa3b, v134
    v_mul_f32 v152, 0xbfb8aa3b, v135
    v_exp_f32 v148, v148
    v_exp_f32 v152, v152
    v_add_f32 v148, 1.0, v148
    v_add_f32 v152, 1.0, v152
    v_rcp_f32 v149, v148
    v_rcp_f32 v153, v152
    v_mul_f32 v150, v134, v149
    v_mul_f32 v154, v135, v153
    v_fma_f32 v151, -v150, v148, v134
    v_fma_f32 v155, -v154, v152, v135
    v_fma_f32 v150, v151, v149, v150
    v_fma_f32 v154, v155, v153, v154
    v_cvt_pk_bf16_f32 v134, v150, v150
    v_cvt_pk_bf16_f32 v135, v154, v154
    v_mul_f32 v148, 0xbfb8aa3b, v136
    v_mul_f32 v152, 0xbfb8aa3b, v137
    v_exp_f32 v148, v148
    v_exp_f32 v152, v152
    v_add_f32 v148, 1.0, v148
    v_add_f32 v152, 1.0, v152
    v_rcp_f32 v149, v148
    v_rcp_f32 v153, v152
    v_mul_f32 v150, v136, v149
    v_mul_f32 v154, v137, v153
    v_fma_f32 v151, -v150, v148, v136
    v_fma_f32 v155, -v154, v152, v137
    v_fma_f32 v150, v151, v149, v150
    v_fma_f32 v154, v155, v153, v154
    v_cvt_pk_bf16_f32 v136, v150, v150
    v_cvt_pk_bf16_f32 v137, v154, v154
    v_mul_f32 v148, 0xbfb8aa3b, v138
    v_mul_f32 v152, 0xbfb8aa3b, v139
    v_exp_f32 v148, v148
    v_exp_f32 v152, v152
    v_add_f32 v148, 1.0, v148
    v_add_f32 v152, 1.0, v152
    v_rcp_f32 v149, v148
    v_rcp_f32 v153, v152
    v_mul_f32 v150, v138, v149
    v_mul_f32 v154, v139, v153
    v_fma_f32 v151, -v150, v148, v138
    v_fma_f32 v155, -v154, v152, v139
    v_fma_f32 v150, v151, v149, v150
    v_fma_f32 v154, v155, v153, v154
    v_cvt_pk_bf16_f32 v138, v150, v150
    v_cvt_pk_bf16_f32 v139, v154, v154
    v_mul_f32 v148, 0xbfb8aa3b, v140
    v_mul_f32 v152, 0xbfb8aa3b, v141
    v_exp_f32 v148, v148
    v_exp_f32 v152, v152
    v_add_f32 v148, 1.0, v148
    v_add_f32 v152, 1.0, v152
    v_rcp_f32 v149, v148
    v_rcp_f32 v153, v152
    v_mul_f32 v150, v140, v149
    v_mul_f32 v154, v141, v153
    v_fma_f32 v151, -v150, v148, v140
    v_fma_f32 v155, -v154, v152, v141
    v_fma_f32 v150, v151, v149, v150
    v_fma_f32 v154, v155, v153, v154
    v_cvt_pk_bf16_f32 v140, v150, v150
    v_cvt_pk_bf16_f32 v141, v154, v154
    v_lshlrev_b32 v8, 1, v8
    ds_write_b64 v8, v[132:133] offset:0
    ds_write_b64 v8, v[134:135] offset:8
    ds_write_b64 v8, v[136:137] offset:16
    ds_write_b64 v8, v[138:139] offset:24
    ds_write_b64 v8, v[140:141] offset:32
    s_waitcnt lgkmcnt(0)
    s_branch L_FINISH
L_FINISH:
    s_endpgm
L_sl5:
    buffer_store_dwordx4 v[24:27], v153, s[28:31], s40 offen sc1
    buffer_store_dwordx2 v[30:31], v108, s[28:31], s40 offen offset:512 sc1
    s_branch L_sd6
L_sl7:
    buffer_store_dwordx4 v[40:43], v140, s[28:31], s41 offen sc1
    s_branch L_sd8
L_sl19:
    buffer_store_dwordx4 v[96:99], v59, s[28:31], s46 offen offset:0 sc1
    buffer_store_dwordx4 v[100:103], v59, s[28:31], s46 offen offset:128 sc1
    buffer_store_dwordx4 v[104:107], v59, s[28:31], s46 offen offset:256 sc1
    buffer_store_dwordx4 v[108:111], v59, s[28:31], s46 offen offset:384 sc1
    buffer_store_dwordx4 v[112:115], v59, s[28:31], s46 offen offset:512 sc1
    buffer_store_dwordx4 v[116:119], v59, s[28:31], s46 offen offset:640 sc1
    buffer_store_dwordx4 v[120:123], v59, s[28:31], s46 offen offset:768 sc1
    buffer_store_dwordx4 v[124:127], v59, s[28:31], s46 offen offset:896 sc1
    buffer_store_dwordx4 v[128:131], v59, s[28:31], s46 offen offset:1024 sc1
    buffer_store_dwordx4 v[132:135], v59, s[28:31], s46 offen offset:1152 sc1
    s_branch L_sd20
L_sl24:
    buffer_store_dwordx4 v[132:135], v8, s[28:31], s43 offen sc1
    buffer_store_dwordx2 v[136:137], v11, s[28:31], s43 offen offset:512 sc1
    s_branch L_sd25
L_END:
    s_endpgm
.section .rodata,"a"
.p2align 6
.amdhsa_kernel adaLN_cond__sliding_block_cached__mixer_token_mlp__decode_kernel
  .amdhsa_next_free_vgpr 168
  .amdhsa_next_free_sgpr 102
  .amdhsa_accum_offset 168
  .amdhsa_group_segment_fixed_size 0
  .amdhsa_kernarg_size 120
  .amdhsa_user_sgpr_count 2
  .amdhsa_user_sgpr_kernarg_segment_ptr 1
  .amdhsa_system_sgpr_workgroup_id_x 1
.end_amdhsa_kernel
```
